```python
import torch

def _softmax(x, axis=-1):
    return torch.softmax(x, dim=axis)
def _gelu(x):
    return torch.nn.functional.gelu(x, approximate="tanh")
def _silu(x):
    return torch.nn.functional.silu(x)
def _sigmoid(x):
    return torch.sigmoid(x)
def _layernorm(x, axis=-1, eps=1e-5):
    m = x.mean(dim=axis, keepdim=True)
    v = x.var(dim=axis, keepdim=True, unbiased=False)
    return (x - m) / torch.sqrt(v + eps)
def _scatter_add(tgt, idx, src, axis=0):
    return tgt.clone().index_add_(axis, idx, src)
def _segment_sum(src, seg, n):
    out = torch.zeros((n,) + src.shape[1:], dtype=src.dtype)
    return out.index_add_(0, seg, src)
def _pad(x, pw):
    flat = tuple(v for pair in reversed(pw) for v in pair)
    return torch.nn.functional.pad(x, flat)

kernel_name = 'recurrent_scan__spectral_gfnet__glu_gated_glu__prompt'

def setup_inputs():

    _w = (lambda a: (lambda t: t.to(torch.bfloat16) if t.is_floating_point() else t)(torch.as_tensor(a)))
    def _A_setup():
        B, S, D = 1, 2048, 448
        Df = D // 2 + 1
        return {
            "x": _w((lambda *s: torch.randn(*s, dtype=torch.bfloat16) * 0.05)(B, S, D)),
            "w_r": _w((lambda *s: torch.randn(*s, dtype=torch.bfloat16) * 0.2)(S, Df) * 0.02),
            "w_i": _w((lambda *s: torch.randn(*s, dtype=torch.bfloat16) * 0.2)(S, Df) * 0.02),
        }
    _A_in = _A_setup()

    def _B_setup():
        B, S, D, F = 1, 2048, 448, 1792
        return {
            "x": _w((lambda *s: torch.randn(*s, dtype=torch.bfloat16) * 0.05)(B, S, D)),
            "w_gate": _w((lambda *s: torch.randn(*s, dtype=torch.bfloat16) * 0.2)(D, F)),
            "w_up": _w((lambda *s: torch.randn(*s, dtype=torch.bfloat16) * 0.1)(D, F)),
            "w_down": _w((lambda *s: torch.randn(*s, dtype=torch.bfloat16) * 0.1)(F, D)),
        }
    _B_in = _B_setup()

    return {
        "A_x": _A_in["x"],
        "A_w_r": _A_in["w_r"],
        "A_w_i": _A_in["w_i"],
        "B_x": _B_in["x"],
        "B_w_gate": _B_in["w_gate"],
        "B_w_up": _B_in["w_up"],
        "B_w_down": _B_in["w_down"],
    }

def reference(A_x, A_w_r, A_w_i, B_x, B_w_gate, B_w_up, B_w_down):
    def _A_ref(x, w_r, w_i):
        B, S, D = x.shape
        X = (lambda x, axes=(-2,-1): torch.fft.rfft2(x.float(), dim=axes))(x, axes=(-2, -1))
        W = w_r + 1j * w_i
        X = X * W
        y = (lambda x, s, axes=(-2,-1): torch.fft.irfft2(x, s=s, dim=axes).to(torch.bfloat16))(X, (S, D), axes=(-2, -1))
        return y

    def _B_ref(x, w_gate, w_up, w_down):
        g = torch.einsum("bsd,df->bsf", x, w_gate)
        u = torch.einsum("bsd,df->bsf", x, w_up)
        h = _sigmoid(g) * u
        return torch.einsum("bsf,fd->bsd", h, w_down)

    x = A_x
    xn = _layernorm(x, axis=-1)
    s = _A_ref(xn, A_w_r, A_w_i)
    g = _silu(_B_ref(xn, B_w_gate, B_w_up, B_w_down))
    return x + s * g
```

```asm
; @launch grid=(256,1,1) block=(512,1,1) lds=163840
.amdgcn_target "amdgcn-amd-amdhsa--gfx950"
.text
.globl recurrent_scan__spectral_gfnet__glu_gated_glu__prompt_kernel
.p2align 12
.type recurrent_scan__spectral_gfnet__glu_gated_glu__prompt_kernel,@function
recurrent_scan__spectral_gfnet__glu_gated_glu__prompt_kernel:
  s_cmp_ge_u32 s2, 256
  s_cbranch_scc1 L_exit
  s_load_dwordx16 s[4:19], s[0:1], 0
  s_load_dwordx4 s[20:23], s[0:1], 64
  v_lshrrev_b32 v3, 6, v0
  v_and_b32 v1, 63, v0
  v_lshlrev_b32 v2, 4, v1
  v_lshrrev_b32 v9, 5, v1
  v_and_b32 v10, 31, v0
  v_readfirstlane_b32 s48, v3
  s_cmp_lt_u32 s2, 32
  s_cbranch_scc0 L_glu
  s_cmp_lt_u32 s48, 2
  s_cbranch_scc0 L_spare
  s_getpc_b64 s[56:57]
L_pc:
  s_sub_u32 s56, s56, L_pc-recurrent_scan__spectral_gfnet__glu_gated_glu__prompt_kernel
  s_subb_u32 s57, s57, 0
  s_lshr_b32 s58, s2, 3
  s_lshl_b32 s58, s58, 7
  v_lshl_add_u32 v3, v0, 9, s58
  v_min_u32 v3, L_code_end-recurrent_scan__spectral_gfnet__glu_gated_glu__prompt_kernel-4, v3
  global_load_dword v8, v3, s[56:57]
  s_branch L_spare
L_glu:
  s_sub_u32 s56, s2, 32
  s_lshr_b32 s56, s56, 3
  s_and_b32 s57, s56, 3
  s_lshr_b32 s53, s56, 2
  s_and_b32 s58, s2, 7
  s_lshl_b32 s52, s58, 2
  s_add_u32 s52, s52, s57
  s_lshr_b32 s50, s58, 1
  s_lshl_b32 s50, s50, 2
  s_add_u32 s50, s50, s57
  s_and_b32 s51, s2, 1
  s_mul_i32 s51, s51, 7
  s_add_u32 s51, s51, s53
  s_and_b32 s49, s48, 3
  s_lshr_b32 s54, s49, 1
  s_and_b32 s55, s49, 1
  s_lshr_b32 s56, s50, 1
  s_add_u32 s3, s53, s56
  s_cmp_ge_u32 s3, 7
  s_cselect_b32 s56, 7, 0
  s_sub_u32 s3, s3, s56
  s_cmp_lt_u32 s48, 4
  s_cbranch_scc0 L_B
  s_setprio 2
  v_lshrrev_b32 v3, 3, v1
  v_lshrrev_b32 v4, 4, v1
  v_and_b32 v5, 7, v1
  v_xor_b32 v4, v4, v5
  v_lshlrev_b32 v4, 4, v4
  s_mov_b32 s56, 57344
  v_mad_u32_u24 v47, v3, s56, v4
  v_xor_b32 v48, 64, v47
  s_lshl_b32 s56, s50, 2
  s_add_u32 s59, s56, s49
  s_mul_i32 s64, s59, 7
  s_add_u32 s64, s64, s3
  s_lshl_b32 s64, s64, 7
  s_add_u32 s65, s64, 458752
  s_add_u32 s66, s64, 917504
  s_add_u32 s67, s64, 1376256
  s_mul_i32 s60, s49, 28672
  s_add_u32 s60, s60, 49152
  s_mov_b32 s26, 1835008
  s_mov_b32 s27, 0x20000
  s_mov_b32 s63, s60
  s_sub_u32 s56, s2, 32
  s_lshl_b32 s69, s56, 2
  s_add_u32 s69, s69, s49
  s_lshl_b32 s62, s56, 1
  s_add_u32 s62, s62, s55
  v_lshlrev_b32 v49, 7, v1
  v_mul_u32_u24 v50, 3584, v1
  v_mul_u32_u24 v51, 57344, v10
  s_waitcnt lgkmcnt(0)
  s_mov_b32 s24, s4
  s_and_b32 s25, s5, 0xffff
  s_add_u32 m0, s63, 0
  s_nop 0
  buffer_load_dwordx4 v47, s[24:27], s64 offen lds
  s_add_u32 m0, s63, 1024
  s_nop 0
  buffer_load_dwordx4 v48, s[24:27], s65 offen lds
  s_add_u32 m0, s63, 2048
  s_nop 0
  buffer_load_dwordx4 v47, s[24:27], s66 offen lds
  s_add_u32 m0, s63, 3072
  s_nop 0
  buffer_load_dwordx4 v48, s[24:27], s67 offen lds
  s_cmp_eq_u32 s3, 6
  s_cselect_b32 s58, -6, 1
  s_lshl_b32 s58, s58, 7
  s_add_u32 m0, s63, 4096
  s_add_u32 s64, s64, s58
  buffer_load_dwordx4 v47, s[24:27], s64 offen lds
  s_cmp_lt_u32 s49, 2
  s_cselect_b32 s28, s12, s14
  s_cselect_b32 s29, s13, s15
  s_and_b32 s29, s29, 0xffff
  s_mov_b32 s30, 1605632
  s_mov_b32 s31, 0x20000
  s_add_u32 m0, s63, 5120
  s_add_u32 s65, s65, s58
  buffer_load_dwordx4 v48, s[24:27], s65 offen lds
  v_lshrrev_b32 v3, 3, v1
  v_bfe_u32 v4, v1, 4, 1
  s_and_b32 s56, s49, 2
  v_or_b32 v4, s56, v4
  v_lshlrev_b32 v4, 1, v4
  v_and_b32 v5, 7, v1
  s_add_u32 m0, s63, 6144
  s_add_u32 s66, s66, s58
  buffer_load_dwordx4 v47, s[24:27], s66 offen lds
  v_xor_b32 v4, v4, v5
  v_lshlrev_b32 v4, 4, v4
  s_movk_i32 s56, 3584
  v_mad_u32_u24 v58, v3, s56, v4
  s_and_b32 s56, s49, 1
  s_mul_i32 s56, s56, 28672
  s_add_u32 m0, s63, 7168
  s_add_u32 s67, s67, s58
  buffer_load_dwordx4 v48, s[24:27], s67 offen lds
  s_lshl_b32 s61, s51, 8
  s_add_u32 s61, s61, s56
  s_lshl_b32 s60, s49, 10
  s_add_u32 s60, s60, 8192
  s_add_u32 s14, s61, 1605632
  s_mul_i32 s56, s3, 229376
  s_cmp_eq_u32 s3, 5
  s_cselect_b32 s58, -6, 1
  s_lshl_b32 s58, s58, 7
  s_add_u32 m0, s63, 8192
  s_add_u32 s64, s64, s58
  buffer_load_dwordx4 v47, s[24:27], s64 offen lds
  s_add_u32 s61, s61, s56
  s_mul_i32 s59, s54, 57344
  s_add_u32 s59, s59, 49152
  v_bfe_u32 v3, v10, 1, 3
  v_xor_b32 v3, v3, v9
  v_lshlrev_b32 v3, 4, v3
  s_add_u32 m0, s63, 9216
  s_add_u32 s65, s65, s58
  buffer_load_dwordx4 v48, s[24:27], s65 offen lds
  v_lshl_add_u32 v3, v10, 7, v3
  v_add_u32 v52, s59, v3
  v_xor_b32 v53, 32, v52
  v_xor_b32 v54, 64, v52
  v_xor_b32 v55, 96, v52
  s_lshl_b32 s59, s55, 1
  s_add_u32 m0, s63, 10240
  s_add_u32 s66, s66, s58
  buffer_load_dwordx4 v47, s[24:27], s66 offen lds
  v_bfe_u32 v3, v1, 4, 1
  v_lshlrev_b32 v4, 1, v3
  v_bfe_u32 v5, v1, 3, 1
  v_or_b32 v4, v4, v5
  v_xor_b32 v4, s59, v4
  v_lshlrev_b32 v4, 5, v4
  s_add_u32 m0, s63, 11264
  s_add_u32 s67, s67, s58
  buffer_load_dwordx4 v48, s[24:27], s67 offen lds
  v_lshl_add_u32 v4, v3, 11, v4
  v_lshl_add_u32 v4, v9, 10, v4
  v_bfe_u32 v5, v1, 2, 2
  v_lshl_add_u32 v4, v5, 7, v4
  v_and_b32 v5, 3, v1
  v_lshl_add_u32 v4, v5, 3, v4
  v_add_u32 v56, 8192, v4
  v_xor_b32 v57, 32, v56
  s_mov_b32 s36, s16
  s_and_b32 s37, s17, 0xffff
  s_mov_b32 s38, 1605632
  s_mov_b32 s39, 0x20000
  v_lshrrev_b32 v3, 3, v1
  v_bfe_u32 v4, v1, 4, 1
  v_lshlrev_b32 v4, 2, v4
  v_and_b32 v5, 7, v1
  v_xor_b32 v4, v4, v5
  v_lshlrev_b32 v4, 4, v4
  s_movk_i32 s56, 896
  v_mad_u32_u24 v59, v3, s56, v4
  s_mul_i32 s68, s55, 802816
  s_mul_i32 s56, s54, 28672
  s_add_u32 s68, s68, s56
  s_lshl_b32 s56, s53, 7
  s_add_u32 s68, s68, s56
  s_mov_b32 s32, s22
  s_and_b32 s33, s23, 0xffff
  s_mov_b32 s34, 17825792
  s_mov_b32 s35, 0x20000
  s_branch L_A0b
L_B:
  s_lshl_b32 s56, s51, 3
  s_add_u32 s56, s56, 1
  s_sub_u32 s57, 224, s56
  v_and_b32 v3, 7, v1
  v_xor_b32 v4, 3, v3
  v_sub_u32 v4, s57, v4
  v_add_u32 v3, s56, v3
  v_cmp_eq_u32 vcc, 112, v4
  v_mov_b32 v5, 224
  s_nop 0
  v_cndmask_b32 v4, v4, v5, vcc
  v_and_b32 v5, 8, v1
  v_cmp_eq_u32 vcc, 0, v5
  s_nop 1
  v_cndmask_b32 v3, v4, v3, vcc
  v_cvt_f32_u32 v3, v3
  v_mul_f32 v3, 0x3b124925, v3
  s_add_u32 s56, s49, s3
  s_lshl_b32 s56, s56, 6
  v_lshl_add_u32 v4, v9, 3, s56
  v_cvt_f32_u32 v4, v4
  v_bfe_u32 v5, v1, 4, 1
  v_cvt_f32_u32 v5, v5
  v_mul_f32 v5, 0x3e800000, v5
  v_fma_f32 v4, v4, v3, v5
  v_fract_f32 v4, v4
  s_lshl_b32 s56, s49, 12
  v_add_u32 v5, s56, v2
  v_mov_b32 v44, 0
  v_mov_b32 v45, 0
  v_fmamk_f32 v12, v3, 0x00000000, v4
  v_fmamk_f32 v13, v3, 0x3f800000, v4
  v_fmamk_f32 v14, v3, 0x40000000, v4
  v_fmamk_f32 v15, v3, 0x40400000, v4
  v_fmamk_f32 v16, v3, 0x40800000, v4
  v_fmamk_f32 v17, v3, 0x40a00000, v4
  v_fmamk_f32 v18, v3, 0x40c00000, v4
  v_fmamk_f32 v19, v3, 0x40e00000, v4
  v_cos_f32 v12, v12
  v_cos_f32 v13, v13
  v_cos_f32 v14, v14
  v_cos_f32 v15, v15
  v_cos_f32 v16, v16
  v_cos_f32 v17, v17
  v_cos_f32 v18, v18
  v_cos_f32 v19, v19
  v_cvt_pk_bf16_f32 v200, v12, v13
  v_cvt_pk_bf16_f32 v201, v14, v15
  v_cvt_pk_bf16_f32 v202, v16, v17
  v_cvt_pk_bf16_f32 v203, v18, v19
  ds_write_b128 v5, v[200:203] offset:32768
  v_fmamk_f32 v20, v3, 0x41800000, v4
  v_fmamk_f32 v21, v3, 0x41880000, v4
  v_fmamk_f32 v22, v3, 0x41900000, v4
  v_fmamk_f32 v23, v3, 0x41980000, v4
  v_fmamk_f32 v24, v3, 0x41a00000, v4
  v_fmamk_f32 v25, v3, 0x41a80000, v4
  v_fmamk_f32 v26, v3, 0x41b00000, v4
  v_fmamk_f32 v27, v3, 0x41b80000, v4
  v_cos_f32 v20, v20
  v_cos_f32 v21, v21
  v_cos_f32 v22, v22
  v_cos_f32 v23, v23
  v_cos_f32 v24, v24
  v_cos_f32 v25, v25
  v_cos_f32 v26, v26
  v_cos_f32 v27, v27
  v_cvt_pk_bf16_f32 v204, v20, v21
  v_cvt_pk_bf16_f32 v205, v22, v23
  v_cvt_pk_bf16_f32 v206, v24, v25
  v_cvt_pk_bf16_f32 v207, v26, v27
  ds_write_b128 v5, v[204:207] offset:33792
  v_fmamk_f32 v12, v3, 0x42000000, v4
  v_fmamk_f32 v13, v3, 0x42040000, v4
  v_fmamk_f32 v14, v3, 0x42080000, v4
  v_fmamk_f32 v15, v3, 0x420c0000, v4
  v_fmamk_f32 v16, v3, 0x42100000, v4
  v_fmamk_f32 v17, v3, 0x42140000, v4
  v_fmamk_f32 v18, v3, 0x42180000, v4
  v_fmamk_f32 v19, v3, 0x421c0000, v4
  v_cos_f32 v12, v12
  v_cos_f32 v13, v13
  v_cos_f32 v14, v14
  v_cos_f32 v15, v15
  v_cos_f32 v16, v16
  v_cos_f32 v17, v17
  v_cos_f32 v18, v18
  v_cos_f32 v19, v19
  v_cvt_pk_bf16_f32 v208, v12, v13
  v_cvt_pk_bf16_f32 v209, v14, v15
  v_cvt_pk_bf16_f32 v210, v16, v17
  v_cvt_pk_bf16_f32 v211, v18, v19
  ds_write_b128 v5, v[208:211] offset:34816
  v_fmamk_f32 v20, v3, 0x42400000, v4
  v_fmamk_f32 v21, v3, 0x42440000, v4
  v_fmamk_f32 v22, v3, 0x42480000, v4
  v_fmamk_f32 v23, v3, 0x424c0000, v4
  v_fmamk_f32 v24, v3, 0x42500000, v4
  v_fmamk_f32 v25, v3, 0x42540000, v4
  v_fmamk_f32 v26, v3, 0x42580000, v4
  v_fmamk_f32 v27, v3, 0x425c0000, v4
  v_cos_f32 v20, v20
  v_cos_f32 v21, v21
  v_cos_f32 v22, v22
  v_cos_f32 v23, v23
  v_cos_f32 v24, v24
  v_cos_f32 v25, v25
  v_cos_f32 v26, v26
  v_cos_f32 v27, v27
  v_cvt_pk_bf16_f32 v212, v20, v21
  v_cvt_pk_bf16_f32 v213, v22, v23
  v_cvt_pk_bf16_f32 v214, v24, v25
  v_cvt_pk_bf16_f32 v215, v26, v27
  ds_write_b128 v5, v[212:215] offset:35840
  s_branch L_B0b
L_A0b:
  s_waitcnt vmcnt(8)
  s_barrier
  s_cmp_eq_u32 s3, 4
  s_cselect_b32 s58, -6, 1
  s_lshl_b32 s58, s58, 7
  s_add_u32 m0, s63, 12288
  s_add_u32 s64, s64, s58
  buffer_load_dwordx4 v47, s[24:27], s64 offen lds
  s_add_u32 m0, s63, 13312
  s_add_u32 s65, s65, s58
  buffer_load_dwordx4 v48, s[24:27], s65 offen lds
  s_add_u32 m0, s63, 14336
  s_add_u32 s66, s66, s58
  buffer_load_dwordx4 v47, s[24:27], s66 offen lds
  s_add_u32 m0, s63, 15360
  s_add_u32 s67, s67, s58
  buffer_load_dwordx4 v48, s[24:27], s67 offen lds
  s_waitcnt vmcnt(8)
  s_barrier
  s_cmp_eq_u32 s3, 3
  s_cselect_b32 s58, -6, 1
  s_lshl_b32 s58, s58, 7
  s_add_u32 m0, s63, 16384
  s_add_u32 s64, s64, s58
  buffer_load_dwordx4 v47, s[24:27], s64 offen lds
  s_add_u32 m0, s63, 17408
  s_add_u32 s65, s65, s58
  buffer_load_dwordx4 v48, s[24:27], s65 offen lds
  s_add_u32 m0, s63, 18432
  s_add_u32 s66, s66, s58
  buffer_load_dwordx4 v47, s[24:27], s66 offen lds
  s_add_u32 m0, s63, 19456
  s_add_u32 s67, s67, s58
  buffer_load_dwordx4 v48, s[24:27], s67 offen lds
  s_sub_u32 s56, s2, 32
  s_lshl_b32 s57, s55, 6
  s_lshl_b32 s56, s56, 1
  s_add_u32 s56, s56, s54
  s_and_b32 s0, s56, 0x3e0
  s_add_u32 s56, s56, s0
  s_mul_i32 s56, s56, 1792
  s_add_u32 s56, s56, 57344
  s_add_u32 s56, s56, s57
  s_mov_b32 s0, s16
  s_mov_b32 s1, s17
  s_add_u32 s0, s0, s56
  s_addc_u32 s1, s1, 0
  s_load_dword s44, s[0:1], 0x0
  s_load_dword s44, s[0:1], 0x80
  s_load_dword s44, s[0:1], 0x100
  s_load_dword s44, s[0:1], 0x180
  s_load_dword s44, s[0:1], 0x200
  s_load_dword s44, s[0:1], 0x280
  s_load_dword s44, s[0:1], 0x300
  s_load_dword s44, s[0:1], 0x380
  s_load_dword s44, s[0:1], 0x400
  s_load_dword s44, s[0:1], 0x480
  s_load_dword s44, s[0:1], 0x500
  s_load_dword s44, s[0:1], 0x580
  s_load_dword s44, s[0:1], 0x600
  s_load_dword s44, s[0:1], 0x680
  s_waitcnt vmcnt(8)
  s_barrier
  s_cmp_eq_u32 s3, 2
  s_cselect_b32 s58, -6, 1
  s_lshl_b32 s58, s58, 7
  s_add_u32 m0, s63, 20480
  s_add_u32 s64, s64, s58
  buffer_load_dwordx4 v47, s[24:27], s64 offen lds
  s_add_u32 m0, s63, 21504
  s_add_u32 s65, s65, s58
  buffer_load_dwordx4 v48, s[24:27], s65 offen lds
  s_add_u32 m0, s63, 22528
  s_add_u32 s66, s66, s58
  buffer_load_dwordx4 v47, s[24:27], s66 offen lds
  s_add_u32 m0, s63, 23552
  s_add_u32 s67, s67, s58
  buffer_load_dwordx4 v48, s[24:27], s67 offen lds
  s_waitcnt vmcnt(8)
  s_barrier
  s_cmp_eq_u32 s3, 1
  s_cselect_b32 s58, -6, 1
  s_lshl_b32 s58, s58, 7
  s_add_u32 m0, s63, 24576
  s_add_u32 s64, s64, s58
  buffer_load_dwordx4 v47, s[24:27], s64 offen lds
  s_add_u32 m0, s63, 25600
  s_add_u32 s65, s65, s58
  buffer_load_dwordx4 v48, s[24:27], s65 offen lds
  s_add_u32 m0, s63, 26624
  s_add_u32 s66, s66, s58
  buffer_load_dwordx4 v47, s[24:27], s66 offen lds
  s_add_u32 m0, s63, 27648
  s_add_u32 s67, s67, s58
  buffer_load_dwordx4 v48, s[24:27], s67 offen lds
  s_waitcnt vmcnt(8)
  s_barrier
  s_add_u32 m0, s60, 0
  s_nop 0
  buffer_load_dwordx4 v58, s[28:31], s61 offen lds
  s_add_u32 m0, s60, 4096
  s_add_u32 s61, s61, 57344
  buffer_load_dwordx4 v58, s[28:31], s61 offen lds
  s_add_u32 m0, s60, 8192
  s_add_u32 s61, s61, 57344
  buffer_load_dwordx4 v58, s[28:31], s61 offen lds
  s_add_u32 m0, s60, 12288
  s_add_u32 s61, s61, 57344
  buffer_load_dwordx4 v58, s[28:31], s61 offen lds
  s_waitcnt vmcnt(8)
  s_barrier
  s_add_u32 m0, s60, 16384
  s_add_u32 s61, s61, 57344
  s_cmp_ge_u32 s61, s14
  s_cselect_b32 s15, 1605632, 0
  s_sub_u32 s61, s61, s15
  buffer_load_dwordx4 v58, s[28:31], s61 offen lds
  s_add_u32 m0, s60, 20480
  s_add_u32 s61, s61, 57344
  buffer_load_dwordx4 v58, s[28:31], s61 offen lds
  s_add_u32 m0, s60, 24576
  s_add_u32 s61, s61, 57344
  buffer_load_dwordx4 v58, s[28:31], s61 offen lds
  s_add_u32 m0, s60, 28672
  s_add_u32 s61, s61, 57344
  buffer_load_dwordx4 v58, s[28:31], s61 offen lds
  s_add_u32 s3, s68, 57344
  buffer_load_dwordx4 v[144:147], v59, s[36:39], s3 offen
  s_add_u32 s3, s68, 64512
  buffer_load_dwordx4 v[148:151], v59, s[36:39], s3 offen
  s_add_u32 s3, s68, 172032
  buffer_load_dwordx4 v[152:155], v59, s[36:39], s3 offen
  s_add_u32 s3, s68, 179200
  buffer_load_dwordx4 v[156:159], v59, s[36:39], s3 offen
  s_branch L_A1
L_B0b:
  v_lshrrev_b32 v3, 1, v10
  v_cvt_f32_u32 v3, v3
  v_lshlrev_b32 v4, 31, v10
  v_xor_b32 v3, v4, v3
  v_cmp_eq_u32 vcc, 1, v10
  v_mov_b32 v4, 0x41800000
  s_nop 0
  v_cndmask_b32 v3, v3, v4, vcc
  v_mul_f32 v3, 0x3d000000, v3
  s_lshl_b32 s56, s50, 2
  s_add_u32 s56, s56, s49
  v_lshl_add_u32 v4, v9, 8, s56
  v_cvt_f32_u32 v4, v4
  v_mul_f32 v4, 0x3c800000, v4
  v_mul_f32 v4, v4, v3
  s_lshl_b32 s58, s49, 11
  v_add_u32 v160, s58, v2
  v_fmamk_f32 v12, v3, 0x00000000, v4
  v_fmamk_f32 v13, v3, 0x3f800000, v4
  v_fmamk_f32 v14, v3, 0x40000000, v4
  v_fmamk_f32 v15, v3, 0x40400000, v4
  v_fmamk_f32 v16, v3, 0x41000000, v4
  v_fmamk_f32 v17, v3, 0x41100000, v4
  v_fmamk_f32 v18, v3, 0x41200000, v4
  v_fmamk_f32 v19, v3, 0x41300000, v4
  v_sin_f32 v20, v12
  v_sin_f32 v21, v13
  v_sin_f32 v22, v14
  v_sin_f32 v23, v15
  v_sin_f32 v24, v16
  v_sin_f32 v25, v17
  v_sin_f32 v26, v18
  v_sin_f32 v27, v19
  v_cos_f32 v12, v12
  v_cos_f32 v13, v13
  v_cos_f32 v14, v14
  v_cos_f32 v15, v15
  v_cos_f32 v16, v16
  v_cos_f32 v17, v17
  v_cos_f32 v18, v18
  v_cos_f32 v19, v19
  v_cvt_pk_bf16_f32 v148, v20, v21
  v_cvt_pk_bf16_f32 v149, v22, v23
  v_cvt_pk_bf16_f32 v150, v24, v25
  v_cvt_pk_bf16_f32 v151, v26, v27
  v_cvt_pk_bf16_f32 v140, v12, v13
  v_cvt_pk_bf16_f32 v141, v14, v15
  v_cvt_pk_bf16_f32 v142, v16, v17
  v_cvt_pk_bf16_f32 v143, v18, v19
  v_fmamk_f32 v12, v3, 0x41800000, v4
  v_fmamk_f32 v13, v3, 0x41880000, v4
  v_fmamk_f32 v14, v3, 0x41900000, v4
  v_fmamk_f32 v15, v3, 0x41980000, v4
  v_fmamk_f32 v16, v3, 0x41c00000, v4
  v_fmamk_f32 v17, v3, 0x41c80000, v4
  v_fmamk_f32 v18, v3, 0x41d00000, v4
  v_fmamk_f32 v19, v3, 0x41d80000, v4
  v_sin_f32 v20, v12
  v_sin_f32 v21, v13
  v_sin_f32 v22, v14
  v_sin_f32 v23, v15
  v_sin_f32 v24, v16
  v_sin_f32 v25, v17
  v_sin_f32 v26, v18
  v_sin_f32 v27, v19
  v_cos_f32 v12, v12
  v_cos_f32 v13, v13
  v_cos_f32 v14, v14
  v_cos_f32 v15, v15
  v_cos_f32 v16, v16
  v_cos_f32 v17, v17
  v_cos_f32 v18, v18
  v_cos_f32 v19, v19
  v_cvt_pk_bf16_f32 v152, v20, v21
  v_cvt_pk_bf16_f32 v153, v22, v23
  v_cvt_pk_bf16_f32 v154, v24, v25
  v_cvt_pk_bf16_f32 v155, v26, v27
  v_cvt_pk_bf16_f32 v144, v12, v13
  v_cvt_pk_bf16_f32 v145, v14, v15
  v_cvt_pk_bf16_f32 v146, v16, v17
  v_cvt_pk_bf16_f32 v147, v18, v19
  s_mul_i32 s60, s49, 28672
  s_add_u32 s60, s60, 49152
  s_mov_b32 s63, 0x3f803f80
  v_bfe_u32 v3, v10, 1, 3
  v_xor_b32 v3, v3, v9
  v_lshlrev_b32 v3, 4, v3
  v_lshl_add_u32 v3, v10, 7, v3
  v_add_u32 v52, s60, v3
  v_xor_b32 v53, 32, v52
  v_xor_b32 v54, 64, v52
  v_xor_b32 v55, 96, v52
  s_waitcnt lgkmcnt(0)
  s_setprio 1
  s_barrier
  ds_read_b128 v[12:15], v52 offset:0
  ds_read_b128 v[16:19], v53 offset:0
  ds_read_b128 v[20:23], v54 offset:0
  ds_read_b128 v[24:27], v55 offset:0
  ds_read_b128 v[200:203], v2 offset:32768
  ds_read_b128 v[204:207], v2 offset:33792
  ds_read_b128 v[208:211], v2 offset:34816
  ds_read_b128 v[212:215], v2 offset:35840
  ds_read_b128 v[216:219], v2 offset:36864
  ds_read_b128 v[220:223], v2 offset:37888
  ds_read_b128 v[224:227], v2 offset:38912
  ds_read_b128 v[228:231], v2 offset:39936
  s_waitcnt lgkmcnt(11)
  v_dot2c_f32_bf16 v45, v12, v12
  v_dot2c_f32_bf16 v44, s63, v12
  v_dot2c_f32_bf16 v45, v13, v13
  v_dot2c_f32_bf16 v44, s63, v13
  v_dot2c_f32_bf16 v45, v14, v14
  v_dot2c_f32_bf16 v44, s63, v14
  v_dot2c_f32_bf16 v45, v15, v15
  v_dot2c_f32_bf16 v44, s63, v15
  s_waitcnt lgkmcnt(10)
  v_dot2c_f32_bf16 v45, v16, v16
  v_dot2c_f32_bf16 v44, s63, v16
  v_dot2c_f32_bf16 v45, v17, v17
  v_dot2c_f32_bf16 v44, s63, v17
  v_dot2c_f32_bf16 v45, v18, v18
  v_dot2c_f32_bf16 v44, s63, v18
  v_dot2c_f32_bf16 v45, v19, v19
  v_dot2c_f32_bf16 v44, s63, v19
  s_waitcnt lgkmcnt(9)
  v_dot2c_f32_bf16 v45, v20, v20
  v_dot2c_f32_bf16 v44, s63, v20
  v_dot2c_f32_bf16 v45, v21, v21
  v_dot2c_f32_bf16 v44, s63, v21
  v_dot2c_f32_bf16 v45, v22, v22
  v_dot2c_f32_bf16 v44, s63, v22
  v_dot2c_f32_bf16 v45, v23, v23
  v_dot2c_f32_bf16 v44, s63, v23
  s_waitcnt lgkmcnt(8)
  v_dot2c_f32_bf16 v45, v24, v24
  v_dot2c_f32_bf16 v44, s63, v24
  v_dot2c_f32_bf16 v45, v25, v25
  v_dot2c_f32_bf16 v44, s63, v25
  v_dot2c_f32_bf16 v45, v26, v26
  v_dot2c_f32_bf16 v44, s63, v26
  v_dot2c_f32_bf16 v45, v27, v27
  v_dot2c_f32_bf16 v44, s63, v27
  s_waitcnt lgkmcnt(7)
  v_mfma_f32_32x32x16_bf16 v[76:91], v[12:15], v[200:203], 0
  ds_read_b128 v[232:235], v2 offset:40960
  ds_read_b128 v[236:239], v2 offset:41984
  ds_read_b128 v[240:243], v2 offset:43008
  ds_read_b128 v[244:247], v2 offset:44032
  ds_read_b128 v[248:251], v2 offset:45056
  ds_read_b128 v[252:255], v2 offset:46080
  s_waitcnt lgkmcnt(12)
  v_mfma_f32_32x32x16_bf16 v[76:91], v[16:19], v[204:207], v[76:91]
  s_barrier
  ds_read_b128 v[28:31], v52 offset:4096
  ds_read_b128 v[32:35], v53 offset:4096
  ds_read_b128 v[36:39], v54 offset:4096
  ds_read_b128 v[40:43], v55 offset:4096
  s_waitcnt lgkmcnt(15)
  v_mfma_f32_32x32x16_bf16 v[76:91], v[20:23], v[208:211], v[76:91]
  s_mov_b32 s44, s20
  s_and_b32 s45, s21, 0xffff
  s_mov_b32 s46, 256
  s_mov_b32 s47, 0x20000
  s_lshl_b32 s56, s51, 13
  s_lshl_b32 s57, s50, 1
  s_waitcnt lgkmcnt(14)
  v_mfma_f32_32x32x16_bf16 v[76:91], v[24:27], v[212:215], v[76:91]
  s_add_u32 s57, s57, s54
  s_lshl_b32 s57, s57, 7
  s_add_u32 s56, s56, s57
  s_lshl_b32 s57, s55, 12
  s_add_u32 s56, s56, s57
  s_add_u32 s65, s56, 7471104
  s_waitcnt lgkmcnt(3)
  v_dot2c_f32_bf16 v45, v28, v28
  v_dot2c_f32_bf16 v44, s63, v28
  v_dot2c_f32_bf16 v45, v29, v29
  v_dot2c_f32_bf16 v44, s63, v29
  v_dot2c_f32_bf16 v45, v30, v30
  v_dot2c_f32_bf16 v44, s63, v30
  v_dot2c_f32_bf16 v45, v31, v31
  v_dot2c_f32_bf16 v44, s63, v31
  s_waitcnt lgkmcnt(2)
  v_dot2c_f32_bf16 v45, v32, v32
  v_dot2c_f32_bf16 v44, s63, v32
  v_dot2c_f32_bf16 v45, v33, v33
  v_dot2c_f32_bf16 v44, s63, v33
  v_dot2c_f32_bf16 v45, v34, v34
  v_dot2c_f32_bf16 v44, s63, v34
  v_dot2c_f32_bf16 v45, v35, v35
  v_dot2c_f32_bf16 v44, s63, v35
  s_waitcnt lgkmcnt(1)
  v_dot2c_f32_bf16 v45, v36, v36
  v_dot2c_f32_bf16 v44, s63, v36
  v_dot2c_f32_bf16 v45, v37, v37
  v_dot2c_f32_bf16 v44, s63, v37
  v_dot2c_f32_bf16 v45, v38, v38
  v_dot2c_f32_bf16 v44, s63, v38
  v_dot2c_f32_bf16 v45, v39, v39
  v_dot2c_f32_bf16 v44, s63, v39
  s_waitcnt lgkmcnt(0)
  v_dot2c_f32_bf16 v45, v40, v40
  v_dot2c_f32_bf16 v44, s63, v40
  v_dot2c_f32_bf16 v45, v41, v41
  v_dot2c_f32_bf16 v44, s63, v41
  v_dot2c_f32_bf16 v45, v42, v42
  v_dot2c_f32_bf16 v44, s63, v42
  v_dot2c_f32_bf16 v45, v43, v43
  v_dot2c_f32_bf16 v44, s63, v43
  v_mfma_f32_32x32x16_bf16 v[76:91], v[28:31], v[216:219], v[76:91]
  s_add_u32 s66, s65, 917504
  v_lshrrev_b32 v49, 3, v1
  v_xor_b32 v49, v49, v1
  v_lshlrev_b32 v49, 31, v49
  v_mfma_f32_32x32x16_bf16 v[76:91], v[32:35], v[220:223], v[76:91]
  s_barrier
  ds_read_b128 v[12:15], v52 offset:8192
  ds_read_b128 v[16:19], v53 offset:8192
  ds_read_b128 v[20:23], v54 offset:8192
  ds_read_b128 v[24:27], v55 offset:8192
  v_mfma_f32_32x32x16_bf16 v[76:91], v[36:39], v[224:227], v[76:91]
  v_xor_b32 v49, 0xbf800000, v49
  v_lshl_add_u32 v50, v10, 2, s58
  v_lshl_add_u32 v51, v9, 4, s58
  v_lshl_add_u32 v162, v10, 4, s58
  v_mfma_f32_32x32x16_bf16 v[76:91], v[40:43], v[228:231], v[76:91]
  v_lshl_add_u32 v3, v10, 6, s58
  v_bfe_u32 v4, v1, 1, 2
  v_xor_b32 v4, v4, v9
  v_lshl_add_u32 v156, v4, 4, v3
  s_waitcnt lgkmcnt(3)
  v_dot2c_f32_bf16 v45, v12, v12
  v_dot2c_f32_bf16 v44, s63, v12
  v_dot2c_f32_bf16 v45, v13, v13
  v_dot2c_f32_bf16 v44, s63, v13
  v_dot2c_f32_bf16 v45, v14, v14
  v_dot2c_f32_bf16 v44, s63, v14
  v_dot2c_f32_bf16 v45, v15, v15
  v_dot2c_f32_bf16 v44, s63, v15
  s_waitcnt lgkmcnt(2)
  v_dot2c_f32_bf16 v45, v16, v16
  v_dot2c_f32_bf16 v44, s63, v16
  v_dot2c_f32_bf16 v45, v17, v17
  v_dot2c_f32_bf16 v44, s63, v17
  v_dot2c_f32_bf16 v45, v18, v18
  v_dot2c_f32_bf16 v44, s63, v18
  v_dot2c_f32_bf16 v45, v19, v19
  v_dot2c_f32_bf16 v44, s63, v19
  s_waitcnt lgkmcnt(1)
  v_dot2c_f32_bf16 v45, v20, v20
  v_dot2c_f32_bf16 v44, s63, v20
  v_dot2c_f32_bf16 v45, v21, v21
  v_dot2c_f32_bf16 v44, s63, v21
  v_dot2c_f32_bf16 v45, v22, v22
  v_dot2c_f32_bf16 v44, s63, v22
  v_dot2c_f32_bf16 v45, v23, v23
  v_dot2c_f32_bf16 v44, s63, v23
  s_waitcnt lgkmcnt(0)
  v_dot2c_f32_bf16 v45, v24, v24
  v_dot2c_f32_bf16 v44, s63, v24
  v_dot2c_f32_bf16 v45, v25, v25
  v_dot2c_f32_bf16 v44, s63, v25
  v_dot2c_f32_bf16 v45, v26, v26
  v_dot2c_f32_bf16 v44, s63, v26
  v_dot2c_f32_bf16 v45, v27, v27
  v_dot2c_f32_bf16 v44, s63, v27
  v_mfma_f32_32x32x16_bf16 v[76:91], v[12:15], v[232:235], v[76:91]
  v_xor_b32 v157, 32, v156
  v_mov_b32 v158, 0
  s_mov_b32 s56, 114688
  v_lshrrev_b32 v5, 3, v1
  v_mfma_f32_32x32x16_bf16 v[76:91], v[16:19], v[236:239], v[76:91]
  s_barrier
  ds_read_b128 v[28:31], v52 offset:12288
  ds_read_b128 v[32:35], v53 offset:12288
  ds_read_b128 v[36:39], v54 offset:12288
  ds_read_b128 v[40:43], v55 offset:12288
  v_mfma_f32_32x32x16_bf16 v[76:91], v[20:23], v[240:243], v[76:91]
  v_and_b32 v6, 0x70, v2
  v_mad_u32_u24 v161, v5, s56, v6
  v_and_b32 v5, 3, v5
  v_lshlrev_b32 v5, 4, v5
  v_mfma_f32_32x32x16_bf16 v[76:91], v[24:27], v[244:247], v[76:91]
  v_xor_b32 v160, v5, v160
  s_lshl_b32 s56, s51, 7
  s_add_u32 s56, s56, 11169792
  s_movk_i32 s57, 1792
  v_mov_b32 v46, s56
  s_waitcnt lgkmcnt(3)
  v_dot2c_f32_bf16 v45, v28, v28
  v_dot2c_f32_bf16 v44, s63, v28
  v_dot2c_f32_bf16 v45, v29, v29
  v_dot2c_f32_bf16 v44, s63, v29
  v_dot2c_f32_bf16 v45, v30, v30
  v_dot2c_f32_bf16 v44, s63, v30
  v_dot2c_f32_bf16 v45, v31, v31
  v_dot2c_f32_bf16 v44, s63, v31
  s_waitcnt lgkmcnt(2)
  v_dot2c_f32_bf16 v45, v32, v32
  v_dot2c_f32_bf16 v44, s63, v32
  v_dot2c_f32_bf16 v45, v33, v33
  v_dot2c_f32_bf16 v44, s63, v33
  v_dot2c_f32_bf16 v45, v34, v34
  v_dot2c_f32_bf16 v44, s63, v34
  v_dot2c_f32_bf16 v45, v35, v35
  v_dot2c_f32_bf16 v44, s63, v35
  s_waitcnt lgkmcnt(1)
  v_dot2c_f32_bf16 v45, v36, v36
  v_dot2c_f32_bf16 v44, s63, v36
  v_dot2c_f32_bf16 v45, v37, v37
  v_dot2c_f32_bf16 v44, s63, v37
  v_dot2c_f32_bf16 v45, v38, v38
  v_dot2c_f32_bf16 v44, s63, v38
  v_dot2c_f32_bf16 v45, v39, v39
  v_dot2c_f32_bf16 v44, s63, v39
  s_waitcnt lgkmcnt(0)
  v_dot2c_f32_bf16 v45, v40, v40
  v_dot2c_f32_bf16 v44, s63, v40
  v_dot2c_f32_bf16 v45, v41, v41
  v_dot2c_f32_bf16 v44, s63, v41
  v_dot2c_f32_bf16 v45, v42, v42
  v_dot2c_f32_bf16 v44, s63, v42
  v_dot2c_f32_bf16 v45, v43, v43
  v_dot2c_f32_bf16 v44, s63, v43
  v_mfma_f32_32x32x16_bf16 v[76:91], v[28:31], v[248:251], v[76:91]
  v_mad_u32_u24 v46, v1, s57, v46
  v_mov_b32 v47, 1
  v_mov_b32 v48, 1792
  s_mov_b32 s32, s22
  s_and_b32 s33, s23, 0xffff
  v_mfma_f32_32x32x16_bf16 v[76:91], v[32:35], v[252:255], v[76:91]
  s_barrier
  ds_read_b128 v[12:15], v52 offset:16384
  ds_read_b128 v[16:19], v53 offset:16384
  ds_read_b128 v[20:23], v54 offset:16384
  ds_read_b128 v[24:27], v55 offset:16384
  v_mfma_f32_32x32x16_bf16 v[92:107], v[36:39], v[200:203], 0
  s_mov_b32 s34, 17825792
  s_mov_b32 s35, 0x20000
  s_lshl_b32 s59, s55, 1
  v_bfe_u32 v3, v1, 4, 1
  v_lshlrev_b32 v4, 1, v3
  v_mfma_f32_32x32x16_bf16 v[92:107], v[40:43], v[204:207], v[92:107]
  v_bfe_u32 v5, v1, 3, 1
  v_or_b32 v4, v4, v5
  v_xor_b32 v4, s59, v4
  v_lshlrev_b32 v4, 5, v4
  s_waitcnt lgkmcnt(3)
  v_dot2c_f32_bf16 v45, v12, v12
  v_dot2c_f32_bf16 v44, s63, v12
  v_dot2c_f32_bf16 v45, v13, v13
  v_dot2c_f32_bf16 v44, s63, v13
  v_dot2c_f32_bf16 v45, v14, v14
  v_dot2c_f32_bf16 v44, s63, v14
  v_dot2c_f32_bf16 v45, v15, v15
  v_dot2c_f32_bf16 v44, s63, v15
  s_waitcnt lgkmcnt(2)
  v_dot2c_f32_bf16 v45, v16, v16
  v_dot2c_f32_bf16 v44, s63, v16
  v_dot2c_f32_bf16 v45, v17, v17
  v_dot2c_f32_bf16 v44, s63, v17
  v_dot2c_f32_bf16 v45, v18, v18
  v_dot2c_f32_bf16 v44, s63, v18
  v_dot2c_f32_bf16 v45, v19, v19
  v_dot2c_f32_bf16 v44, s63, v19
  s_waitcnt lgkmcnt(1)
  v_dot2c_f32_bf16 v45, v20, v20
  v_dot2c_f32_bf16 v44, s63, v20
  v_dot2c_f32_bf16 v45, v21, v21
  v_dot2c_f32_bf16 v44, s63, v21
  v_dot2c_f32_bf16 v45, v22, v22
  v_dot2c_f32_bf16 v44, s63, v22
  v_dot2c_f32_bf16 v45, v23, v23
  v_dot2c_f32_bf16 v44, s63, v23
  s_waitcnt lgkmcnt(0)
  v_dot2c_f32_bf16 v45, v24, v24
  v_dot2c_f32_bf16 v44, s63, v24
  v_dot2c_f32_bf16 v45, v25, v25
  v_dot2c_f32_bf16 v44, s63, v25
  v_dot2c_f32_bf16 v45, v26, v26
  v_dot2c_f32_bf16 v44, s63, v26
  v_dot2c_f32_bf16 v45, v27, v27
  v_dot2c_f32_bf16 v44, s63, v27
  v_mfma_f32_32x32x16_bf16 v[92:107], v[12:15], v[208:211], v[92:107]
  v_lshl_add_u32 v4, v3, 11, v4
  v_lshl_add_u32 v4, v9, 10, v4
  v_bfe_u32 v5, v1, 2, 2
  v_lshl_add_u32 v4, v5, 7, v4
  buffer_load_dword v59, off, s[44:47], 0 sc1
  v_mfma_f32_32x32x16_bf16 v[92:107], v[16:19], v[212:215], v[92:107]
  s_barrier
  ds_read_b128 v[28:31], v52 offset:20480
  ds_read_b128 v[32:35], v53 offset:20480
  ds_read_b128 v[36:39], v54 offset:20480
  ds_read_b128 v[40:43], v55 offset:20480
  v_mfma_f32_32x32x16_bf16 v[92:107], v[20:23], v[216:219], v[92:107]
  v_and_b32 v5, 3, v1
  v_lshl_add_u32 v4, v5, 3, v4
  v_add_u32 v56, 8192, v4
  v_xor_b32 v57, 32, v56
  v_mfma_f32_32x32x16_bf16 v[92:107], v[24:27], v[220:223], v[92:107]
  s_lshl_b32 s56, s55, 1
  s_xor_b32 s56, s56, s49
  s_lshl_b32 s56, s56, 5
  v_xor_b32 v184, s56, v56
  s_cmp_lt_u32 s50, 14
  s_cselect_b32 s56, 0x100001, 0
  s_waitcnt lgkmcnt(3)
  v_dot2c_f32_bf16 v45, v28, v28
  v_dot2c_f32_bf16 v44, s63, v28
  v_dot2c_f32_bf16 v45, v29, v29
  v_dot2c_f32_bf16 v44, s63, v29
  v_dot2c_f32_bf16 v45, v30, v30
  v_dot2c_f32_bf16 v44, s63, v30
  v_dot2c_f32_bf16 v45, v31, v31
  v_dot2c_f32_bf16 v44, s63, v31
  s_waitcnt lgkmcnt(2)
  v_dot2c_f32_bf16 v45, v32, v32
  v_dot2c_f32_bf16 v44, s63, v32
  v_dot2c_f32_bf16 v45, v33, v33
  v_dot2c_f32_bf16 v44, s63, v33
  v_dot2c_f32_bf16 v45, v34, v34
  v_dot2c_f32_bf16 v44, s63, v34
  v_dot2c_f32_bf16 v45, v35, v35
  v_dot2c_f32_bf16 v44, s63, v35
  s_waitcnt lgkmcnt(1)
  v_dot2c_f32_bf16 v45, v36, v36
  v_dot2c_f32_bf16 v44, s63, v36
  v_dot2c_f32_bf16 v45, v37, v37
  v_dot2c_f32_bf16 v44, s63, v37
  v_dot2c_f32_bf16 v45, v38, v38
  v_dot2c_f32_bf16 v44, s63, v38
  v_dot2c_f32_bf16 v45, v39, v39
  v_dot2c_f32_bf16 v44, s63, v39
  s_waitcnt lgkmcnt(0)
  v_dot2c_f32_bf16 v45, v40, v40
  v_dot2c_f32_bf16 v44, s63, v40
  v_dot2c_f32_bf16 v45, v41, v41
  v_dot2c_f32_bf16 v44, s63, v41
  v_dot2c_f32_bf16 v45, v42, v42
  v_dot2c_f32_bf16 v44, s63, v42
  v_dot2c_f32_bf16 v45, v43, v43
  v_dot2c_f32_bf16 v44, s63, v43
  v_mfma_f32_32x32x16_bf16 v[92:107], v[28:31], v[224:227], v[92:107]
  v_lshrrev_b32 v172, v10, s56
  v_and_b32 v172, 1, v172
  v_mul_u32_u24 v172, 0x3f80, v172
  v_lshl_or_b32 v172, v172, 16, v172
  v_mfma_f32_32x32x16_bf16 v[92:107], v[32:35], v[228:231], v[92:107]
  s_barrier
  ds_read_b128 v[12:15], v52 offset:24576
  ds_read_b128 v[16:19], v53 offset:24576
  ds_read_b128 v[20:23], v54 offset:24576
  ds_read_b128 v[24:27], v55 offset:24576
  v_mfma_f32_32x32x16_bf16 v[92:107], v[36:39], v[232:235], v[92:107]
  v_mov_b32 v173, v172
  v_mov_b64 v[174:175], v[172:173]
  s_lshl_b32 s56, s51, 3
  s_add_u32 s56, s56, s49
  s_lshl_b32 s56, s56, 11
  v_mfma_f32_32x32x16_bf16 v[92:107], v[40:43], v[236:239], v[92:107]
  s_add_u32 s64, s56, 11231232
  s_mov_b32 s24, s4
  s_and_b32 s25, s5, 0xffff
  s_mov_b32 s26, 1835008
  s_mov_b32 s27, 0x20000
  s_cmp_lt_u32 s49, 2
  s_cselect_b32 s28, s12, s14
  s_cselect_b32 s29, s13, s15
  s_waitcnt lgkmcnt(3)
  v_dot2c_f32_bf16 v45, v12, v12
  v_dot2c_f32_bf16 v44, s63, v12
  v_dot2c_f32_bf16 v45, v13, v13
  v_dot2c_f32_bf16 v44, s63, v13
  v_dot2c_f32_bf16 v45, v14, v14
  v_dot2c_f32_bf16 v44, s63, v14
  v_dot2c_f32_bf16 v45, v15, v15
  v_dot2c_f32_bf16 v44, s63, v15
  s_waitcnt lgkmcnt(2)
  v_dot2c_f32_bf16 v45, v16, v16
  v_dot2c_f32_bf16 v44, s63, v16
  v_dot2c_f32_bf16 v45, v17, v17
  v_dot2c_f32_bf16 v44, s63, v17
  v_dot2c_f32_bf16 v45, v18, v18
  v_dot2c_f32_bf16 v44, s63, v18
  v_dot2c_f32_bf16 v45, v19, v19
  v_dot2c_f32_bf16 v44, s63, v19
  s_waitcnt lgkmcnt(1)
  v_dot2c_f32_bf16 v45, v20, v20
  v_dot2c_f32_bf16 v44, s63, v20
  v_dot2c_f32_bf16 v45, v21, v21
  v_dot2c_f32_bf16 v44, s63, v21
  v_dot2c_f32_bf16 v45, v22, v22
  v_dot2c_f32_bf16 v44, s63, v22
  v_dot2c_f32_bf16 v45, v23, v23
  v_dot2c_f32_bf16 v44, s63, v23
  s_waitcnt lgkmcnt(0)
  v_dot2c_f32_bf16 v45, v24, v24
  v_dot2c_f32_bf16 v44, s63, v24
  v_dot2c_f32_bf16 v45, v25, v25
  v_dot2c_f32_bf16 v44, s63, v25
  v_dot2c_f32_bf16 v45, v26, v26
  v_dot2c_f32_bf16 v44, s63, v26
  v_dot2c_f32_bf16 v45, v27, v27
  v_dot2c_f32_bf16 v44, s63, v27
  s_and_b32 s29, s29, 0xffff
  s_mov_b32 s30, 1605632
  s_mov_b32 s31, 0x20000
  v_lshrrev_b32 v3, 3, v1
  v_bfe_u32 v4, v1, 4, 1
  s_and_b32 s56, s49, 2
  v_or_b32 v4, s56, v4
  v_lshlrev_b32 v4, 1, v4
  v_and_b32 v5, 7, v1
  v_xor_b32 v4, v4, v5
  v_lshlrev_b32 v4, 4, v4
  s_movk_i32 s56, 3584
  v_mad_u32_u24 v58, v3, s56, v4
  s_and_b32 s56, s49, 1
  s_mul_i32 s56, s56, 28672
  s_lshl_b32 s61, s51, 8
  s_add_u32 s61, s61, s56
  s_lshl_b32 s60, s49, 10
  s_add_u32 s60, s60, 8192
  s_add_u32 s61, s61, 128
  s_cmp_ge_u32 s3, 4
  s_cselect_b32 s56, -4, 3
  s_add_u32 s3, s3, s56
  s_add_u32 s14, s61, 1605632
  s_mul_i32 s56, s3, 229376
  s_add_u32 s61, s61, s56
  s_barrier
  ds_read_b64_tr_b16 v[164:165], v184 offset:0
  ds_read_b64_tr_b16 v[166:167], v184 offset:512
  ds_read_b64_tr_b16 v[168:169], v184 offset:4096
  ds_read_b64_tr_b16 v[170:171], v184 offset:4608
  v_mov_b32 v3, v44
  v_mov_b32 v4, v45
  v_mfma_f32_32x32x16_bf16 v[92:107], v[12:15], v[240:243], v[92:107]
  v_permlane32_swap_b32 v3, v44
  v_permlane32_swap_b32 v4, v45
  v_add_f32 v3, v3, v44
  v_add_f32 v4, v4, v45
  v_mul_f32 v3, 0xbb124925, v3
  v_mfma_f32_32x32x16_bf16 v[92:107], v[16:19], v[244:247], v[92:107]
  v_mul_f32 v5, -v3, v3
  v_fmamk_f32 v4, v4, 0x3b124925, v5
  v_max_f32 v4, 0, v4
  v_add_f32 v4, 0x3727c5ac, v4
  v_rsq_f32 v5, v4
  v_mfma_f32_32x32x16_bf16 v[92:107], v[20:23], v[248:251], v[92:107]
  ds_write_b32 v50, v5 offset:1536
  ds_read_b128 v[28:31], v51 offset:1536
  ds_read_b128 v[32:35], v51 offset:1568
  ds_read_b128 v[36:39], v51 offset:1600
  ds_read_b128 v[40:43], v51 offset:1632
  v_mfma_f32_32x32x16_bf16 v[92:107], v[24:27], v[252:255], v[92:107]
  v_mul_f32 v64, 0xbfb8aa3b, v5
  v_mul_f32 v65, v4, v5
  v_cvt_pk_bf16_f32 v66, v3, v3
  v_and_b32 v4, 0xffff0000, v66
  v_sub_f32 v4, v3, v4
  v_cvt_pk_bf16_f32 v67, v4, 0
  s_nop 5
  v_fmac_f32 v76, v92, v49
  v_fmac_f32 v77, v93, v49
  v_fmac_f32 v78, v94, v49
  v_fmac_f32 v79, v95, v49
  v_fmac_f32 v80, v96, v49
  v_fmac_f32 v81, v97, v49
  v_fmac_f32 v82, v98, v49
  v_fmac_f32 v83, v99, v49
  s_waitcnt lgkmcnt(3)
  v_mul_f32 v76, v76, v28
  v_mul_f32 v77, v77, v29
  v_mul_f32 v78, v78, v30
  v_mul_f32 v79, v79, v31
  s_waitcnt lgkmcnt(2)
  v_mul_f32 v80, v80, v32
  v_mul_f32 v81, v81, v33
  v_mul_f32 v82, v82, v34
  v_mul_f32 v83, v83, v35
  v_cvt_pk_bf16_f32 v12, v76, v77
  v_cvt_pk_bf16_f32 v13, v78, v79
  v_cvt_pk_bf16_f32 v14, v80, v81
  v_cvt_pk_bf16_f32 v15, v82, v83
  s_nop 1
  v_mfma_f32_32x32x16_bf16 v[108:123], v[12:15], v[140:143], 0
  v_mfma_f32_16x16x32_bf16 v[176:179], v[172:175], v[164:167], 0
  v_mfma_f32_16x16x32_bf16 v[176:179], v[172:175], v[168:171], v[176:179]
  s_barrier
  ds_read_b64_tr_b16 v[164:165], v184 offset:8192
  ds_read_b64_tr_b16 v[166:167], v184 offset:8704
  ds_read_b64_tr_b16 v[168:169], v184 offset:12288
  ds_read_b64_tr_b16 v[170:171], v184 offset:12800
  v_mfma_f32_32x32x16_bf16 v[124:139], v[12:15], v[148:151], 0
  v_fmac_f32 v84, v100, v49
  v_fmac_f32 v85, v101, v49
  v_fmac_f32 v86, v102, v49
  v_fmac_f32 v87, v103, v49
  v_fmac_f32 v88, v104, v49
  v_fmac_f32 v89, v105, v49
  v_fmac_f32 v90, v106, v49
  v_fmac_f32 v91, v107, v49
  s_waitcnt lgkmcnt(5)
  v_mul_f32 v84, v84, v36
  v_mul_f32 v85, v85, v37
  v_mul_f32 v86, v86, v38
  v_mul_f32 v87, v87, v39
  s_waitcnt lgkmcnt(4)
  v_mul_f32 v88, v88, v40
  v_mul_f32 v89, v89, v41
  v_mul_f32 v90, v90, v42
  v_mul_f32 v91, v91, v43
  v_cvt_pk_bf16_f32 v16, v84, v85
  v_cvt_pk_bf16_f32 v17, v86, v87
  v_cvt_pk_bf16_f32 v18, v88, v89
  v_cvt_pk_bf16_f32 v19, v90, v91
  s_nop 1
  v_mfma_f32_32x32x16_bf16 v[108:123], v[16:19], v[144:147], v[108:123]
  v_mfma_f32_32x32x16_bf16 v[124:139], v[16:19], v[152:155], v[124:139]
  s_nop 11
  v_add_f32 v108, v108, v132
  v_add_f32 v109, v109, v133
  v_add_f32 v110, v110, v134
  v_add_f32 v111, v111, v135
  v_add_f32 v112, v112, v136
  v_add_f32 v113, v113, v137
  v_add_f32 v114, v114, v138
  s_waitcnt lgkmcnt(2)
  v_mfma_f32_16x16x32_bf16 v[180:183], v[172:175], v[164:167], 0
  s_waitcnt lgkmcnt(0)
  v_mfma_f32_16x16x32_bf16 v[180:183], v[172:175], v[168:171], v[180:183]
  s_barrier
  s_mov_b32 s62, 0
  s_waitcnt vmcnt(0)
L_chk1:
  v_cmp_gt_u32 vcc, 32, v59
  s_cbranch_vccz L_cend2
  s_add_u32 s62, s62, 1
  s_cmp_gt_u32 s62, 0x8000
  s_cbranch_scc1 L_cend2
  buffer_load_dword v59, off, s[44:47], 0 sc1
  s_waitcnt vmcnt(0)
  s_branch L_chk1
L_cend2:
  s_bitcmp1_b32 s50, 0
  s_cselect_b64 vcc, -1, 0
  s_nop 0
  v_cndmask_b32 v176, v176, v180, vcc
  s_lshl_b32 s62, s50, 7
  v_lshl_add_u32 v177, v10, 2, s62
  v_or_b32 v176, 1, v176
  s_mov_b32 exec_hi, 0
  buffer_store_dword v176, v177, s[32:35], s64 offen sc1
  s_mov_b64 exec, -1
  v_add_f32 v115, v115, v139
  v_cvt_pk_bf16_f32 v12, v108, v109
  v_cvt_pk_bf16_f32 v14, v112, v113
  v_cvt_pk_bf16_f32 v13, v110, v111
  v_cvt_pk_bf16_f32 v15, v114, v115
  v_permlane32_swap_b32 v12, v14
  s_nop 0
  v_permlane32_swap_b32 v13, v15
  ds_write_b128 v156, v[12:15]
  v_sub_f32 v116, v116, v124
  v_sub_f32 v117, v117, v125
  v_sub_f32 v118, v118, v126
  v_sub_f32 v119, v119, v127
  v_sub_f32 v120, v120, v128
  v_sub_f32 v121, v121, v129
  v_sub_f32 v122, v122, v130
  v_sub_f32 v123, v123, v131
  v_cvt_pk_bf16_f32 v16, v116, v117
  v_cvt_pk_bf16_f32 v18, v120, v121
  v_cvt_pk_bf16_f32 v17, v118, v119
  v_cvt_pk_bf16_f32 v19, v122, v123
  v_permlane32_swap_b32 v16, v18
  s_nop 0
  v_permlane32_swap_b32 v17, v19
  ds_write_b128 v157, v[16:19]
  ds_read_b128 v[20:23], v160 offset:0
  ds_read_b128 v[24:27], v160 offset:1024
  ds_write_b128 v162, v[64:67] offset:1024
  ds_write_b32 v50, v158 offset:1792
  s_barrier
  s_waitcnt lgkmcnt(3)
  buffer_store_dwordx4 v[20:23], v161, s[32:35], s65 offen sc1
  s_waitcnt lgkmcnt(2)
  buffer_store_dwordx4 v[24:27], v161, s[32:35], s66 offen sc1
  s_setprio 0
  s_mul_i32 s59, s55, 28672
  v_subrev_u32 v52, s59, v52
  v_subrev_u32 v53, s59, v53
  v_subrev_u32 v54, s59, v54
  v_subrev_u32 v55, s59, v55
  s_lshl_b32 s56, s55, 12
  v_lshl_add_u32 v60, v1, 2, s56
  s_lshl_b32 s56, s54, 12
  s_add_u32 s56, s56, 1024
  v_lshl_add_u32 v61, v10, 4, s56
  s_lshl_b32 s56, s50, 1
  s_add_u32 s56, s56, s54
  s_mul_i32 s69, s56, 231424
  s_mul_i32 s57, s55, 28
  s_add_u32 s57, s57, s51
  s_lshl_b32 s57, s57, 10
  s_add_u32 s69, s69, s57
  s_mul_i32 s56, s56, 896
  s_lshl_b32 s57, s55, 2
  s_add_u32 s56, s56, s57
  s_add_u32 s56, s56, 11141136
  v_mov_b32 v63, 1
  v_lshl_add_u32 v62, v1, 7, s56
  v_lshlrev_b32 v204, 5, v10
  v_lshl_add_u32 v204, v9, 4, v204
  s_sub_u32 s56, s2, 32
  s_lshl_b32 s56, s56, 7
  s_barrier
  s_add_u32 s7, s56, 11184128
  s_mul_i32 s56, s52, 57344
  s_mul_i32 s57, s55, 28672
  s_add_u32 s56, s56, s57
  s_mul_i32 s57, s54, 14336
  s_add_u32 s56, s56, s57
  s_add_u32 s8, s56, 9306112
  s_lshl_b32 s56, s53, 6
  s_add_u32 s56, s56, s55
  v_lshl_add_u32 v208, v10, 1, s56
  v_cvt_f32_u32 v208, v208
  v_mul_f32 v208, 0x3b124925, v208
  s_mul_i32 s56, s54, 56
  s_add_u32 s56, s56, 1
  v_lshl_add_u32 v209, v9, 2, s56
  v_cvt_f32_u32 v209, v209
  v_mul_f32 v209, v209, v208
  v_and_b32 v210, s54, v9
  v_lshlrev_b32 v210, s55, v210
  v_lshrrev_b32 v3, 3, v1
  v_and_b32 v4, 0x70, v2
  s_mov_b32 s56, 57344
  v_mad_u32_u24 v214, v3, s56, v4
  s_lshl_b32 s56, s49, 9
  s_lshl_b32 s57, s52, 1
  s_add_u32 s56, s56, s57
  s_mul_i32 s56, s56, 896
  s_lshl_b32 s57, s53, 7
  s_add_u32 s9, s56, s57
  s_mov_b32 s40, s18
  s_and_b32 s41, s19, 0xffff
  s_mov_b32 s42, 1835008
  s_mov_b32 s43, 0x20000
  s_barrier
  ds_read_b128 v[172:175], v52 offset:0
  ds_read_b128 v[176:179], v52 offset:28672
  ds_read_b128 v[180:183], v53 offset:0
  ds_read_b128 v[184:187], v53 offset:28672
  ds_read_b128 v[188:191], v54 offset:0
  ds_read_b128 v[192:195], v54 offset:28672
  ds_read_b128 v[196:199], v55 offset:0
  ds_read_b128 v[200:203], v55 offset:28672
  s_barrier
  s_waitcnt vmcnt(0)
  s_mov_b64 exec, 1
  ds_add_rtn_u32 v48, v48, v47
  s_waitcnt lgkmcnt(0)
  v_cmp_eq_u32 vcc, 3, v48
  s_cbranch_vccz L_bsig3
  s_mov_b64 exec, 0xff
  buffer_atomic_add v47, v46, s[32:35], 0 offen sc1
L_bsig3:
  s_mov_b64 exec, -1
  s_barrier
  ds_read_b128 v[216:219], v52 offset:4096
  ds_read_b128 v[220:223], v52 offset:32768
  ds_read_b128 v[224:227], v53 offset:4096
  ds_read_b128 v[228:231], v53 offset:32768
  ds_read_b128 v[232:235], v54 offset:4096
  ds_read_b128 v[236:239], v54 offset:32768
  ds_read_b128 v[240:243], v55 offset:4096
  ds_read_b128 v[244:247], v55 offset:32768
  s_barrier
  ds_read_b128 v[140:143], v52 offset:8192
  ds_read_b128 v[144:147], v52 offset:36864
  ds_read_b128 v[148:151], v53 offset:8192
  ds_read_b128 v[152:155], v53 offset:36864
  ds_read_b128 v[156:159], v54 offset:8192
  ds_read_b128 v[160:163], v54 offset:36864
  ds_read_b128 v[164:167], v55 offset:8192
  ds_read_b128 v[168:171], v55 offset:36864
  s_waitcnt lgkmcnt(0)
  s_barrier
  buffer_load_dwordx4 v[12:15], v2, s[32:35], s64 offen offset:0 sc1
  buffer_load_dwordx4 v[16:19], v2, s[32:35], s64 offen offset:1024 sc1
  v_and_b32 v21, 7, v1
  v_lshrrev_b32 v20, 4, v1
  v_lshl_add_u32 v21, v21, 2, v20
  v_and_b32 v20, 8, v1
  v_lshl_add_u32 v21, v20, 2, v21
  s_lshl_b32 s62, s49, 11
  v_lshl_add_u32 v21, v21, 2, s62
  s_mov_b32 s67, s56
  s_mov_b32 s3, s57
  s_sub_u32 s56, s2, 32
  s_lshl_b32 s57, s55, 6
  s_lshl_b32 s56, s56, 1
  s_add_u32 s56, s56, s54
  s_and_b32 s0, s56, 0x3e0
  s_add_u32 s56, s56, s0
  s_mul_i32 s56, s56, 1792
  s_add_u32 s56, s56, 0
  s_add_u32 s56, s56, s57
  s_mov_b32 s0, s16
  s_mov_b32 s1, s17
  s_add_u32 s0, s0, s56
  s_addc_u32 s1, s1, 0
  s_load_dword s68, s[0:1], 0x0
  s_load_dword s68, s[0:1], 0x80
  s_load_dword s68, s[0:1], 0x100
  s_load_dword s68, s[0:1], 0x180
  s_load_dword s68, s[0:1], 0x200
  s_load_dword s68, s[0:1], 0x280
  s_load_dword s68, s[0:1], 0x300
  s_load_dword s68, s[0:1], 0x380
  s_load_dword s68, s[0:1], 0x400
  s_load_dword s68, s[0:1], 0x480
  s_load_dword s68, s[0:1], 0x500
  s_load_dword s68, s[0:1], 0x580
  s_load_dword s68, s[0:1], 0x600
  s_load_dword s68, s[0:1], 0x680
  s_mov_b32 s56, s67
  s_mov_b32 s57, s3
  s_barrier
  s_add_u32 m0, s60, 32768
  s_nop 0
  buffer_load_dwordx4 v58, s[28:31], s61 offen lds
  s_add_u32 m0, s60, 36864
  s_add_u32 s61, s61, 57344
  buffer_load_dwordx4 v58, s[28:31], s61 offen lds
  s_barrier
  s_add_u32 m0, s60, 0
  s_add_u32 s61, s61, 57344
  buffer_load_dwordx4 v58, s[28:31], s61 offen lds
  s_add_u32 m0, s60, 4096
  s_add_u32 s61, s61, 57344
  buffer_load_dwordx4 v58, s[28:31], s61 offen lds
  s_mov_b32 s62, 0
  s_waitcnt vmcnt(4)
L_chk4:
  v_min3_u32 v20, v12, v13, v14
  v_min3_u32 v20, v20, v15, v16
  v_min3_u32 v20, v20, v17, v18
  v_min_u32 v20, v20, v19
  v_cmp_eq_u32 vcc, 0, v20
  s_cbranch_vccz L_cend5
  s_add_u32 s62, s62, 1
  s_cmp_gt_u32 s62, 0x8000
  s_cbranch_scc1 L_cend5
  buffer_load_dwordx4 v[12:15], v2, s[32:35], s64 offen offset:0 sc1
  buffer_load_dwordx4 v[16:19], v2, s[32:35], s64 offen offset:1024 sc1
  s_waitcnt vmcnt(0)
  s_branch L_chk4
L_cend5:
  v_add_f32 v12, v12, v16
  v_add_f32 v13, v13, v17
  v_add_f32 v14, v14, v18
  v_add_f32 v15, v15, v19
  s_barrier
  s_add_u32 m0, s60, 8192
  s_add_u32 s61, s61, 57344
  s_cmp_ge_u32 s61, s14
  s_cselect_b32 s15, 1605632, 0
  s_sub_u32 s61, s61, s15
  buffer_load_dwordx4 v58, s[28:31], s61 offen lds
  s_add_u32 m0, s60, 12288
  s_add_u32 s61, s61, 57344
  buffer_load_dwordx4 v58, s[28:31], s61 offen lds
  v_permlane16_swap_b32 v12, v13
  v_permlane16_swap_b32 v14, v15
  v_add_f32 v12, v12, v13
  v_add_f32 v14, v14, v15
  s_nop 1
  v_permlane32_swap_b32 v12, v14
  v_add_f32 v12, v12, v14
  v_cvt_pk_bf16_f32 v13, v12, v12
  v_and_b32 v13, 0xffff0000, v13
  v_sub_f32 v13, v12, v13
  v_cvt_pk_bf16_f32 v12, v12, v13
  ds_write_b32 v21, v12 offset:1536
  ds_read_b32 v20, v21
  s_waitcnt lgkmcnt(1)
  s_barrier
  s_add_u32 m0, s60, 16384
  s_add_u32 s61, s61, 57344
  buffer_load_dwordx4 v58, s[28:31], s61 offen lds
  s_add_u32 m0, s60, 20480
  s_add_u32 s61, s61, 57344
  buffer_load_dwordx4 v58, s[28:31], s61 offen lds
  s_waitcnt lgkmcnt(0)
  s_waitcnt vmcnt(6)
  s_setprio 2
  s_barrier
  ds_read_b64_tr_b16 v[28:29], v56 offset:32768
  ds_read_b64_tr_b16 v[30:31], v56 offset:33280
  ds_read_b128 v[12:15], v52 offset:12288
  ds_read_b64_tr_b16 v[32:33], v57 offset:32768
  ds_read_b64_tr_b16 v[34:35], v57 offset:33280
  ds_read_b128 v[16:19], v52 offset:40960
  ds_read_b64_tr_b16 v[36:37], v56 offset:36864
  ds_read_b64_tr_b16 v[38:39], v56 offset:37376
  ds_read_b64_tr_b16 v[40:41], v57 offset:36864
  ds_read_b64_tr_b16 v[42:43], v57 offset:37376
  s_waitcnt lgkmcnt(7)
  v_mfma_f32_32x32x16_bf16 v[76:91], v[28:31], v[12:15], 0
  ds_read_b128 v[20:23], v53 offset:12288
  s_add_u32 m0, s60, 24576
  s_add_u32 s61, s61, 57344
  s_cmp_ge_u32 s61, s14
  s_cselect_b32 s15, 1605632, 0
  s_sub_u32 s61, s61, s15
  buffer_load_dwordx4 v58, s[28:31], s61 offen lds
  s_waitcnt lgkmcnt(6)
  v_mfma_f32_32x32x16_bf16 v[92:107], v[32:35], v[12:15], 0
  ds_read_b128 v[24:27], v53 offset:40960
  s_waitcnt lgkmcnt(6)
  v_mfma_f32_32x32x16_bf16 v[108:123], v[28:31], v[16:19], 0
  s_add_u32 m0, s60, 28672
  s_add_u32 s61, s61, 57344
  buffer_load_dwordx4 v58, s[28:31], s61 offen lds
  v_mfma_f32_32x32x16_bf16 v[124:139], v[32:35], v[16:19], 0
  s_waitcnt vmcnt(6) lgkmcnt(2)
  s_barrier
  s_waitcnt lgkmcnt(1)
  v_mfma_f32_32x32x16_bf16 v[76:91], v[36:39], v[20:23], v[76:91]
  ds_read_b64_tr_b16 v[44:45], v56 offset:0
  ds_read_b64_tr_b16 v[46:47], v56 offset:512
  ds_read_b128 v[12:15], v54 offset:12288
  v_mfma_f32_32x32x16_bf16 v[92:107], v[40:43], v[20:23], v[92:107]
  ds_read_b64_tr_b16 v[48:49], v57 offset:0
  ds_read_b64_tr_b16 v[50:51], v57 offset:512
  ds_read_b128 v[16:19], v54 offset:40960
  s_waitcnt lgkmcnt(6)
  v_mfma_f32_32x32x16_bf16 v[108:123], v[36:39], v[24:27], v[108:123]
  ds_read_b64_tr_b16 v[28:29], v56 offset:4096
  ds_read_b64_tr_b16 v[30:31], v56 offset:4608
  v_mfma_f32_32x32x16_bf16 v[124:139], v[40:43], v[24:27], v[124:139]
  ds_read_b64_tr_b16 v[32:33], v57 offset:4096
  ds_read_b64_tr_b16 v[34:35], v57 offset:4608
  s_waitcnt lgkmcnt(7)
  v_mfma_f32_32x32x16_bf16 v[76:91], v[44:47], v[12:15], v[76:91]
  ds_read_b128 v[20:23], v55 offset:12288
  s_add_u32 m0, s60, 32768
  s_add_u32 s61, s61, 57344
  buffer_load_dwordx4 v58, s[28:31], s61 offen lds
  s_waitcnt lgkmcnt(6)
  v_mfma_f32_32x32x16_bf16 v[92:107], v[48:51], v[12:15], v[92:107]
  ds_read_b128 v[24:27], v55 offset:40960
  s_waitcnt lgkmcnt(6)
  v_mfma_f32_32x32x16_bf16 v[108:123], v[44:47], v[16:19], v[108:123]
  s_add_u32 m0, s60, 36864
  s_add_u32 s61, s61, 57344
  buffer_load_dwordx4 v58, s[28:31], s61 offen lds
  v_mfma_f32_32x32x16_bf16 v[124:139], v[48:51], v[16:19], v[124:139]
  s_waitcnt vmcnt(6) lgkmcnt(2)
  s_waitcnt lgkmcnt(0)
  s_barrier
  v_mfma_f32_32x32x16_bf16 v[76:91], v[28:31], v[20:23], v[76:91]
  ds_read_b64_tr_b16 v[36:37], v56 offset:8192
  ds_read_b64_tr_b16 v[38:39], v56 offset:8704
  ds_read_b128 v[12:15], v52 offset:16384
  v_mfma_f32_32x32x16_bf16 v[92:107], v[32:35], v[20:23], v[92:107]
  ds_read_b64_tr_b16 v[40:41], v57 offset:8192
  ds_read_b64_tr_b16 v[42:43], v57 offset:8704
  ds_read_b128 v[16:19], v52 offset:45056
  v_mfma_f32_32x32x16_bf16 v[108:123], v[28:31], v[24:27], v[108:123]
  ds_read_b64_tr_b16 v[44:45], v56 offset:12288
  ds_read_b64_tr_b16 v[46:47], v56 offset:12800
  v_mfma_f32_32x32x16_bf16 v[124:139], v[32:35], v[24:27], v[124:139]
  ds_read_b64_tr_b16 v[48:49], v57 offset:12288
  ds_read_b64_tr_b16 v[50:51], v57 offset:12800
  s_waitcnt lgkmcnt(7)
  v_mfma_f32_32x32x16_bf16 v[76:91], v[36:39], v[12:15], v[76:91]
  ds_read_b128 v[20:23], v53 offset:16384
  s_add_u32 m0, s60, 0
  s_add_u32 s61, s61, 57344
  s_cmp_ge_u32 s61, s14
  s_cselect_b32 s15, 1605632, 0
  s_sub_u32 s61, s61, s15
  buffer_load_dwordx4 v58, s[28:31], s61 offen lds
  s_waitcnt lgkmcnt(6)
  v_mfma_f32_32x32x16_bf16 v[92:107], v[40:43], v[12:15], v[92:107]
  ds_read_b128 v[24:27], v53 offset:45056
  s_waitcnt lgkmcnt(6)
  v_mfma_f32_32x32x16_bf16 v[108:123], v[36:39], v[16:19], v[108:123]
  s_add_u32 m0, s60, 4096
  s_add_u32 s61, s61, 57344
  buffer_load_dwordx4 v58, s[28:31], s61 offen lds
  v_mfma_f32_32x32x16_bf16 v[124:139], v[40:43], v[16:19], v[124:139]
  s_waitcnt vmcnt(6) lgkmcnt(2)
  s_barrier
  s_waitcnt lgkmcnt(1)
  v_mfma_f32_32x32x16_bf16 v[76:91], v[44:47], v[20:23], v[76:91]
  ds_read_b64_tr_b16 v[28:29], v56 offset:16384
  ds_read_b64_tr_b16 v[30:31], v56 offset:16896
  ds_read_b128 v[12:15], v54 offset:16384
  v_mfma_f32_32x32x16_bf16 v[92:107], v[48:51], v[20:23], v[92:107]
  ds_read_b64_tr_b16 v[32:33], v57 offset:16384
  ds_read_b64_tr_b16 v[34:35], v57 offset:16896
  ds_read_b128 v[16:19], v54 offset:45056
  s_waitcnt lgkmcnt(6)
  v_mfma_f32_32x32x16_bf16 v[108:123], v[44:47], v[24:27], v[108:123]
  ds_read_b64_tr_b16 v[36:37], v56 offset:20480
  ds_read_b64_tr_b16 v[38:39], v56 offset:20992
  v_mfma_f32_32x32x16_bf16 v[124:139], v[48:51], v[24:27], v[124:139]
  ds_read_b64_tr_b16 v[40:41], v57 offset:20480
  ds_read_b64_tr_b16 v[42:43], v57 offset:20992
  s_waitcnt lgkmcnt(7)
  v_mfma_f32_32x32x16_bf16 v[76:91], v[28:31], v[12:15], v[76:91]
  ds_read_b128 v[20:23], v55 offset:16384
  s_add_u32 m0, s60, 8192
  s_add_u32 s61, s61, 57344
  buffer_load_dwordx4 v58, s[28:31], s61 offen lds
  s_waitcnt lgkmcnt(6)
  v_mfma_f32_32x32x16_bf16 v[92:107], v[32:35], v[12:15], v[92:107]
  ds_read_b128 v[24:27], v55 offset:45056
  s_waitcnt lgkmcnt(6)
  v_mfma_f32_32x32x16_bf16 v[108:123], v[28:31], v[16:19], v[108:123]
  s_add_u32 m0, s60, 12288
  s_add_u32 s61, s61, 57344
  buffer_load_dwordx4 v58, s[28:31], s61 offen lds
  v_mfma_f32_32x32x16_bf16 v[124:139], v[32:35], v[16:19], v[124:139]
  s_waitcnt vmcnt(6) lgkmcnt(2)
  s_waitcnt lgkmcnt(0)
  s_barrier
  v_mfma_f32_32x32x16_bf16 v[76:91], v[36:39], v[20:23], v[76:91]
  ds_read_b64_tr_b16 v[44:45], v56 offset:24576
  ds_read_b64_tr_b16 v[46:47], v56 offset:25088
  ds_read_b128 v[12:15], v52 offset:20480
  v_mfma_f32_32x32x16_bf16 v[92:107], v[40:43], v[20:23], v[92:107]
  ds_read_b64_tr_b16 v[48:49], v57 offset:24576
  ds_read_b64_tr_b16 v[50:51], v57 offset:25088
  ds_read_b128 v[16:19], v52 offset:49152
  v_mfma_f32_32x32x16_bf16 v[108:123], v[36:39], v[24:27], v[108:123]
  ds_read_b64_tr_b16 v[28:29], v56 offset:28672
  ds_read_b64_tr_b16 v[30:31], v56 offset:29184
  v_mfma_f32_32x32x16_bf16 v[124:139], v[40:43], v[24:27], v[124:139]
  ds_read_b64_tr_b16 v[32:33], v57 offset:28672
  ds_read_b64_tr_b16 v[34:35], v57 offset:29184
  s_waitcnt lgkmcnt(7)
  v_mfma_f32_32x32x16_bf16 v[76:91], v[44:47], v[12:15], v[76:91]
  ds_read_b128 v[20:23], v53 offset:20480
  s_add_u32 m0, s60, 16384
  s_add_u32 s61, s61, 57344
  s_cmp_ge_u32 s61, s14
  s_cselect_b32 s15, 1605632, 0
  s_sub_u32 s61, s61, s15
  buffer_load_dwordx4 v58, s[28:31], s61 offen lds
  s_waitcnt lgkmcnt(6)
  v_mfma_f32_32x32x16_bf16 v[92:107], v[48:51], v[12:15], v[92:107]
  ds_read_b128 v[24:27], v53 offset:49152
  s_waitcnt lgkmcnt(6)
  v_mfma_f32_32x32x16_bf16 v[108:123], v[44:47], v[16:19], v[108:123]
  s_add_u32 m0, s60, 20480
  s_add_u32 s61, s61, 57344
  buffer_load_dwordx4 v58, s[28:31], s61 offen lds
  v_mfma_f32_32x32x16_bf16 v[124:139], v[48:51], v[16:19], v[124:139]
  s_waitcnt vmcnt(6) lgkmcnt(2)
  s_barrier
  s_waitcnt lgkmcnt(1)
  v_mfma_f32_32x32x16_bf16 v[76:91], v[28:31], v[20:23], v[76:91]
  ds_read_b64_tr_b16 v[36:37], v56 offset:32768
  ds_read_b64_tr_b16 v[38:39], v56 offset:33280
  ds_read_b128 v[12:15], v54 offset:20480
  v_mfma_f32_32x32x16_bf16 v[92:107], v[32:35], v[20:23], v[92:107]
  ds_read_b64_tr_b16 v[40:41], v57 offset:32768
  ds_read_b64_tr_b16 v[42:43], v57 offset:33280
  ds_read_b128 v[16:19], v54 offset:49152
  s_waitcnt lgkmcnt(6)
  v_mfma_f32_32x32x16_bf16 v[108:123], v[28:31], v[24:27], v[108:123]
  ds_read_b64_tr_b16 v[44:45], v56 offset:36864
  ds_read_b64_tr_b16 v[46:47], v56 offset:37376
  v_mfma_f32_32x32x16_bf16 v[124:139], v[32:35], v[24:27], v[124:139]
  ds_read_b64_tr_b16 v[48:49], v57 offset:36864
  ds_read_b64_tr_b16 v[50:51], v57 offset:37376
  s_waitcnt lgkmcnt(7)
  v_mfma_f32_32x32x16_bf16 v[76:91], v[36:39], v[12:15], v[76:91]
  ds_read_b128 v[20:23], v55 offset:20480
  s_add_u32 m0, s60, 24576
  s_add_u32 s61, s61, 57344
  buffer_load_dwordx4 v58, s[28:31], s61 offen lds
  s_waitcnt lgkmcnt(6)
  v_mfma_f32_32x32x16_bf16 v[92:107], v[40:43], v[12:15], v[92:107]
  ds_read_b128 v[24:27], v55 offset:49152
  s_waitcnt lgkmcnt(6)
  v_mfma_f32_32x32x16_bf16 v[108:123], v[36:39], v[16:19], v[108:123]
  s_add_u32 m0, s60, 28672
  s_add_u32 s61, s61, 57344
  buffer_load_dwordx4 v58, s[28:31], s61 offen lds
  v_mfma_f32_32x32x16_bf16 v[124:139], v[40:43], v[16:19], v[124:139]
  s_waitcnt vmcnt(6) lgkmcnt(2)
  s_waitcnt lgkmcnt(0)
  s_barrier
  v_mfma_f32_32x32x16_bf16 v[76:91], v[44:47], v[20:23], v[76:91]
  ds_read_b64_tr_b16 v[28:29], v56 offset:0
  ds_read_b64_tr_b16 v[30:31], v56 offset:512
  ds_read_b128 v[12:15], v52 offset:24576
  v_mfma_f32_32x32x16_bf16 v[92:107], v[48:51], v[20:23], v[92:107]
  ds_read_b64_tr_b16 v[32:33], v57 offset:0
  ds_read_b64_tr_b16 v[34:35], v57 offset:512
  ds_read_b128 v[16:19], v52 offset:53248
  v_mfma_f32_32x32x16_bf16 v[108:123], v[44:47], v[24:27], v[108:123]
  ds_read_b64_tr_b16 v[36:37], v56 offset:4096
  ds_read_b64_tr_b16 v[38:39], v56 offset:4608
  v_mfma_f32_32x32x16_bf16 v[124:139], v[48:51], v[24:27], v[124:139]
  ds_read_b64_tr_b16 v[40:41], v57 offset:4096
  ds_read_b64_tr_b16 v[42:43], v57 offset:4608
  s_waitcnt lgkmcnt(7)
  v_mfma_f32_32x32x16_bf16 v[76:91], v[28:31], v[12:15], v[76:91]
  ds_read_b128 v[20:23], v53 offset:24576
  s_add_u32 m0, s60, 32768
  s_add_u32 s61, s61, 57344
  s_cmp_ge_u32 s61, s14
  s_cselect_b32 s15, 1605632, 0
  s_sub_u32 s61, s61, s15
  buffer_load_dwordx4 v58, s[28:31], s61 offen lds
  s_waitcnt lgkmcnt(6)
  v_mfma_f32_32x32x16_bf16 v[92:107], v[32:35], v[12:15], v[92:107]
  ds_read_b128 v[24:27], v53 offset:53248
  s_waitcnt lgkmcnt(6)
  v_mfma_f32_32x32x16_bf16 v[108:123], v[28:31], v[16:19], v[108:123]
  s_add_u32 m0, s60, 36864
  s_add_u32 s61, s61, 57344
  buffer_load_dwordx4 v58, s[28:31], s61 offen lds
  v_mfma_f32_32x32x16_bf16 v[124:139], v[32:35], v[16:19], v[124:139]
  s_waitcnt vmcnt(6) lgkmcnt(2)
  s_barrier
  s_waitcnt lgkmcnt(1)
  v_mfma_f32_32x32x16_bf16 v[76:91], v[36:39], v[20:23], v[76:91]
  ds_read_b64_tr_b16 v[44:45], v56 offset:8192
  ds_read_b64_tr_b16 v[46:47], v56 offset:8704
  ds_read_b128 v[12:15], v54 offset:24576
  v_mfma_f32_32x32x16_bf16 v[92:107], v[40:43], v[20:23], v[92:107]
  ds_read_b64_tr_b16 v[48:49], v57 offset:8192
  ds_read_b64_tr_b16 v[50:51], v57 offset:8704
  ds_read_b128 v[16:19], v54 offset:53248
  s_waitcnt lgkmcnt(6)
  v_mfma_f32_32x32x16_bf16 v[108:123], v[36:39], v[24:27], v[108:123]
  ds_read_b64_tr_b16 v[28:29], v56 offset:12288
  ds_read_b64_tr_b16 v[30:31], v56 offset:12800
  v_mfma_f32_32x32x16_bf16 v[124:139], v[40:43], v[24:27], v[124:139]
  ds_read_b64_tr_b16 v[32:33], v57 offset:12288
  ds_read_b64_tr_b16 v[34:35], v57 offset:12800
  s_waitcnt lgkmcnt(7)
  v_mfma_f32_32x32x16_bf16 v[76:91], v[44:47], v[12:15], v[76:91]
  ds_read_b128 v[20:23], v55 offset:24576
  s_add_u32 m0, s60, 0
  s_add_u32 s61, s61, 57344
  buffer_load_dwordx4 v58, s[28:31], s61 offen lds
  s_waitcnt lgkmcnt(6)
  v_mfma_f32_32x32x16_bf16 v[92:107], v[48:51], v[12:15], v[92:107]
  ds_read_b128 v[24:27], v55 offset:53248
  s_waitcnt lgkmcnt(6)
  v_mfma_f32_32x32x16_bf16 v[108:123], v[44:47], v[16:19], v[108:123]
  s_add_u32 m0, s60, 4096
  s_add_u32 s61, s61, 57344
  buffer_load_dwordx4 v58, s[28:31], s61 offen lds
  v_mfma_f32_32x32x16_bf16 v[124:139], v[48:51], v[16:19], v[124:139]
  s_waitcnt vmcnt(6) lgkmcnt(2)
  s_waitcnt lgkmcnt(0)
  s_barrier
  v_mfma_f32_32x32x16_bf16 v[76:91], v[28:31], v[20:23], v[76:91]
  ds_read_b64_tr_b16 v[36:37], v56 offset:16384
  ds_read_b64_tr_b16 v[38:39], v56 offset:16896
  v_mfma_f32_32x32x16_bf16 v[92:107], v[32:35], v[20:23], v[92:107]
  ds_read_b64_tr_b16 v[40:41], v57 offset:16384
  ds_read_b64_tr_b16 v[42:43], v57 offset:16896
  v_mfma_f32_32x32x16_bf16 v[108:123], v[28:31], v[24:27], v[108:123]
  ds_read_b64_tr_b16 v[44:45], v56 offset:20480
  ds_read_b64_tr_b16 v[46:47], v56 offset:20992
  v_mfma_f32_32x32x16_bf16 v[124:139], v[32:35], v[24:27], v[124:139]
  ds_read_b64_tr_b16 v[48:49], v57 offset:20480
  ds_read_b64_tr_b16 v[50:51], v57 offset:20992
  s_waitcnt lgkmcnt(6)
  v_mfma_f32_32x32x16_bf16 v[76:91], v[36:39], v[172:175], v[76:91]
  s_add_u32 m0, s60, 8192
  s_add_u32 s61, s61, 57344
  s_cmp_ge_u32 s61, s14
  s_cselect_b32 s15, 1605632, 0
  s_sub_u32 s61, s61, s15
  buffer_load_dwordx4 v58, s[28:31], s61 offen lds
  s_waitcnt lgkmcnt(4)
  v_mfma_f32_32x32x16_bf16 v[92:107], v[40:43], v[172:175], v[92:107]
  v_mfma_f32_32x32x16_bf16 v[108:123], v[36:39], v[176:179], v[108:123]
  s_add_u32 m0, s60, 12288
  s_add_u32 s61, s61, 57344
  buffer_load_dwordx4 v58, s[28:31], s61 offen lds
  v_mfma_f32_32x32x16_bf16 v[124:139], v[40:43], v[176:179], v[124:139]
  s_waitcnt vmcnt(6) lgkmcnt(0)
  s_barrier
  v_mfma_f32_32x32x16_bf16 v[76:91], v[44:47], v[180:183], v[76:91]
  ds_read_b64_tr_b16 v[28:29], v56 offset:24576
  ds_read_b64_tr_b16 v[30:31], v56 offset:25088
  v_mfma_f32_32x32x16_bf16 v[92:107], v[48:51], v[180:183], v[92:107]
  ds_read_b64_tr_b16 v[32:33], v57 offset:24576
  ds_read_b64_tr_b16 v[34:35], v57 offset:25088
  v_mfma_f32_32x32x16_bf16 v[108:123], v[44:47], v[184:187], v[108:123]
  ds_read_b64_tr_b16 v[36:37], v56 offset:28672
  ds_read_b64_tr_b16 v[38:39], v56 offset:29184
  v_mfma_f32_32x32x16_bf16 v[124:139], v[48:51], v[184:187], v[124:139]
  ds_read_b64_tr_b16 v[40:41], v57 offset:28672
  ds_read_b64_tr_b16 v[42:43], v57 offset:29184
  s_waitcnt lgkmcnt(6)
  v_mfma_f32_32x32x16_bf16 v[76:91], v[28:31], v[188:191], v[76:91]
  s_add_u32 m0, s60, 16384
  s_add_u32 s61, s61, 57344
  buffer_load_dwordx4 v58, s[28:31], s61 offen lds
  s_waitcnt lgkmcnt(4)
  v_mfma_f32_32x32x16_bf16 v[92:107], v[32:35], v[188:191], v[92:107]
  v_mfma_f32_32x32x16_bf16 v[108:123], v[28:31], v[192:195], v[108:123]
  s_add_u32 m0, s60, 20480
  s_add_u32 s61, s61, 57344
  buffer_load_dwordx4 v58, s[28:31], s61 offen lds
  v_mfma_f32_32x32x16_bf16 v[124:139], v[32:35], v[192:195], v[124:139]
  s_waitcnt vmcnt(6) lgkmcnt(0)
  s_barrier
  v_mfma_f32_32x32x16_bf16 v[76:91], v[36:39], v[196:199], v[76:91]
  ds_read_b64_tr_b16 v[44:45], v56 offset:32768
  ds_read_b64_tr_b16 v[46:47], v56 offset:33280
  v_mfma_f32_32x32x16_bf16 v[92:107], v[40:43], v[196:199], v[92:107]
  ds_read_b64_tr_b16 v[48:49], v57 offset:32768
  ds_read_b64_tr_b16 v[50:51], v57 offset:33280
  v_mfma_f32_32x32x16_bf16 v[108:123], v[36:39], v[200:203], v[108:123]
  ds_read_b64_tr_b16 v[28:29], v56 offset:36864
  ds_read_b64_tr_b16 v[30:31], v56 offset:37376
  v_mfma_f32_32x32x16_bf16 v[124:139], v[40:43], v[200:203], v[124:139]
  ds_read_b64_tr_b16 v[32:33], v57 offset:36864
  ds_read_b64_tr_b16 v[34:35], v57 offset:37376
  s_waitcnt lgkmcnt(6)
  v_mfma_f32_32x32x16_bf16 v[76:91], v[44:47], v[216:219], v[76:91]
  s_waitcnt lgkmcnt(4)
  v_mfma_f32_32x32x16_bf16 v[92:107], v[48:51], v[216:219], v[92:107]
  v_mfma_f32_32x32x16_bf16 v[108:123], v[44:47], v[220:223], v[108:123]
  v_mfma_f32_32x32x16_bf16 v[124:139], v[48:51], v[220:223], v[124:139]
  s_waitcnt vmcnt(4) lgkmcnt(0)
  s_barrier
  v_mfma_f32_32x32x16_bf16 v[76:91], v[28:31], v[224:227], v[76:91]
  ds_read_b64_tr_b16 v[36:37], v56 offset:0
  ds_read_b64_tr_b16 v[38:39], v56 offset:512
  v_mfma_f32_32x32x16_bf16 v[92:107], v[32:35], v[224:227], v[92:107]
  ds_read_b64_tr_b16 v[40:41], v57 offset:0
  ds_read_b64_tr_b16 v[42:43], v57 offset:512
  v_mfma_f32_32x32x16_bf16 v[108:123], v[28:31], v[228:231], v[108:123]
  ds_read_b64_tr_b16 v[44:45], v56 offset:4096
  ds_read_b64_tr_b16 v[46:47], v56 offset:4608
  v_mfma_f32_32x32x16_bf16 v[124:139], v[32:35], v[228:231], v[124:139]
  ds_read_b64_tr_b16 v[48:49], v57 offset:4096
  ds_read_b64_tr_b16 v[50:51], v57 offset:4608
  s_waitcnt lgkmcnt(6)
  v_mfma_f32_32x32x16_bf16 v[76:91], v[36:39], v[232:235], v[76:91]
  s_waitcnt lgkmcnt(4)
  v_mfma_f32_32x32x16_bf16 v[92:107], v[40:43], v[232:235], v[92:107]
  ds_read_b128 v[64:67], v61
  ds_read_b128 v[68:71], v61 offset:2048
  v_mfma_f32_32x32x16_bf16 v[108:123], v[36:39], v[236:239], v[108:123]
  v_mfma_f32_32x32x16_bf16 v[124:139], v[40:43], v[236:239], v[124:139]
  s_waitcnt vmcnt(0) lgkmcnt(2)
  s_barrier
  ds_read_b64_tr_b16 v[28:29], v56 offset:8192
  ds_read_b64_tr_b16 v[30:31], v56 offset:8704
  ds_read_b64_tr_b16 v[32:33], v57 offset:8192
  ds_read_b64_tr_b16 v[34:35], v57 offset:8704
  v_mfma_f32_32x32x16_bf16 v[76:91], v[44:47], v[240:243], v[76:91]
  ds_read_b64_tr_b16 v[36:37], v56 offset:12288
  ds_read_b64_tr_b16 v[38:39], v56 offset:12800
  ds_read_b64_tr_b16 v[40:41], v57 offset:12288
  v_mfma_f32_32x32x16_bf16 v[92:107], v[48:51], v[240:243], v[92:107]
  ds_read_b64_tr_b16 v[42:43], v57 offset:12800
  ds_read_b64_tr_b16 v[12:13], v56 offset:16384
  ds_read_b64_tr_b16 v[14:15], v56 offset:16896
  v_mfma_f32_32x32x16_bf16 v[108:123], v[44:47], v[244:247], v[108:123]
  ds_read_b64_tr_b16 v[16:17], v57 offset:16384
  ds_read_b64_tr_b16 v[18:19], v57 offset:16896
  ds_read_b64_tr_b16 v[20:21], v56 offset:20480
  s_waitcnt lgkmcnt(11)
  v_mfma_f32_32x32x16_bf16 v[76:91], v[28:31], v[140:143], v[76:91]
  ds_read_b64_tr_b16 v[22:23], v56 offset:20992
  ds_read_b64_tr_b16 v[24:25], v57 offset:20480
  ds_read_b64_tr_b16 v[26:27], v57 offset:20992
  s_waitcnt lgkmcnt(12)
  v_mfma_f32_32x32x16_bf16 v[92:107], v[32:35], v[140:143], v[92:107]
  ds_read_b32 v72, v60 offset:1536
  ds_read_b32 v74, v60 offset:3584
  s_waitcnt lgkmcnt(12)
  v_mfma_f32_32x32x16_bf16 v[76:91], v[36:39], v[148:151], v[76:91]
  s_waitcnt lgkmcnt(10)
  v_mfma_f32_32x32x16_bf16 v[92:107], v[40:43], v[148:151], v[92:107]
  s_waitcnt lgkmcnt(8)
  v_mfma_f32_32x32x16_bf16 v[76:91], v[12:15], v[156:159], v[76:91]
  s_waitcnt lgkmcnt(6)
  v_mfma_f32_32x32x16_bf16 v[92:107], v[16:19], v[156:159], v[92:107]
  s_waitcnt lgkmcnt(4)
  v_mfma_f32_32x32x16_bf16 v[76:91], v[20:23], v[164:167], v[76:91]
  s_waitcnt lgkmcnt(2)
  v_mfma_f32_32x32x16_bf16 v[92:107], v[24:27], v[164:167], v[92:107]
  s_waitcnt lgkmcnt(1)
  v_and_b32 v73, 0xffff, v72
  s_waitcnt lgkmcnt(0)
  v_and_b32 v75, 0xffff, v74
  s_nop 3
  v_mfma_f32_32x32x8_bf16 v[76:91], v[72:73], v[66:67], v[76:91]
  s_nop 0
  v_mfma_f32_32x32x8_bf16 v[92:107], v[74:75], v[66:67], v[92:107]
  v_mfma_f32_32x32x16_bf16 v[124:139], v[48:51], v[244:247], v[124:139]
  v_mov_b32 v8, 1808
  v_mov_b32 v7, 1
  s_mov_b64 exec, 1
  ds_add_u32 v8, v7
  s_mov_b64 exec, -1
  v_mfma_f32_32x32x16_bf16 v[108:123], v[28:31], v[144:147], v[108:123]
  s_nop 3
  v_mfma_f32_32x32x16_bf16 v[124:139], v[32:35], v[144:147], v[124:139]
  v_mul_f32 v76, v76, v64
  v_mul_f32 v77, v77, v64
  v_mul_f32 v78, v78, v64
  v_mul_f32 v79, v79, v64
  v_mul_f32 v80, v80, v64
  v_mul_f32 v81, v81, v64
  v_mfma_f32_32x32x16_bf16 v[108:123], v[36:39], v[152:155], v[108:123]
  v_mul_f32 v82, v82, v64
  v_mul_f32 v83, v83, v64
  v_exp_f32 v76, v76
  v_exp_f32 v77, v77
  v_mfma_f32_32x32x16_bf16 v[124:139], v[40:43], v[152:155], v[124:139]
  v_exp_f32 v78, v78
  v_exp_f32 v79, v79
  v_exp_f32 v80, v80
  v_mfma_f32_32x32x16_bf16 v[108:123], v[12:15], v[160:163], v[108:123]
  v_exp_f32 v81, v81
  v_exp_f32 v82, v82
  v_exp_f32 v83, v83
  v_mfma_f32_32x32x16_bf16 v[124:139], v[16:19], v[160:163], v[124:139]
  v_fma_f32 v76, v76, v65, v65
  v_fma_f32 v77, v77, v65, v65
  v_fma_f32 v78, v78, v65, v65
  v_fma_f32 v79, v79, v65, v65
  v_fma_f32 v80, v80, v65, v65
  v_fma_f32 v81, v81, v65, v65
  v_mfma_f32_32x32x16_bf16 v[108:123], v[20:23], v[168:171], v[108:123]
  v_fma_f32 v82, v82, v65, v65
  v_fma_f32 v83, v83, v65, v65
  v_rcp_f32 v76, v76
  v_rcp_f32 v77, v77
  v_mfma_f32_32x32x16_bf16 v[124:139], v[24:27], v[168:171], v[124:139]
  v_rcp_f32 v78, v78
  v_rcp_f32 v79, v79
  v_rcp_f32 v80, v80
  s_nop 1
  v_mfma_f32_32x32x8_bf16 v[108:123], v[72:73], v[70:71], v[108:123]
  v_rcp_f32 v81, v81
  v_rcp_f32 v82, v82
  v_rcp_f32 v83, v83
  s_nop 0
  v_mfma_f32_32x32x8_bf16 v[124:139], v[74:75], v[70:71], v[124:139]
  v_mul_f32 v84, v84, v76
  v_mul_f32 v85, v85, v77
  v_mul_f32 v86, v86, v78
  v_mul_f32 v87, v87, v79
  v_mul_f32 v88, v88, v80
  v_mul_f32 v89, v89, v81
  s_setprio 0
  v_mul_f32 v90, v90, v82
  v_mul_f32 v91, v91, v83
  v_cvt_pk_bf16_f32 v76, v84, v85
  v_cvt_pk_bf16_f32 v77, v86, v87
  v_cvt_pk_bf16_f32 v78, v88, v89
  v_cvt_pk_bf16_f32 v79, v90, v91
  s_setprio 3
  s_add_u32 s3, s69, 57344
  buffer_store_dwordx4 v[76:79], v2, s[32:35], s3 offen sc1
  s_setprio 0
  v_mul_f32 v92, v92, v64
  v_mul_f32 v93, v93, v64
  v_mul_f32 v94, v94, v64
  v_mul_f32 v95, v95, v64
  v_mul_f32 v96, v96, v64
  v_mul_f32 v97, v97, v64
  v_mul_f32 v98, v98, v64
  v_mul_f32 v99, v99, v64
  v_exp_f32 v92, v92
  v_exp_f32 v93, v93
  v_exp_f32 v94, v94
  v_exp_f32 v95, v95
  v_exp_f32 v96, v96
  v_exp_f32 v97, v97
  v_exp_f32 v98, v98
  v_exp_f32 v99, v99
  v_fma_f32 v92, v92, v65, v65
  v_fma_f32 v93, v93, v65, v65
  v_fma_f32 v94, v94, v65, v65
  v_fma_f32 v95, v95, v65, v65
  v_fma_f32 v96, v96, v65, v65
  v_fma_f32 v97, v97, v65, v65
  v_fma_f32 v98, v98, v65, v65
  v_fma_f32 v99, v99, v65, v65
  v_rcp_f32 v92, v92
  v_rcp_f32 v93, v93
  v_rcp_f32 v94, v94
  v_rcp_f32 v95, v95
  v_rcp_f32 v96, v96
  v_rcp_f32 v97, v97
  v_rcp_f32 v98, v98
  v_rcp_f32 v99, v99
  v_mul_f32 v100, v100, v92
  v_mul_f32 v101, v101, v93
  v_mul_f32 v102, v102, v94
  v_mul_f32 v103, v103, v95
  v_mul_f32 v104, v104, v96
  v_mul_f32 v105, v105, v97
  v_mul_f32 v106, v106, v98
  v_mul_f32 v107, v107, v99
  v_cvt_pk_bf16_f32 v92, v100, v101
  v_cvt_pk_bf16_f32 v93, v102, v103
  v_cvt_pk_bf16_f32 v94, v104, v105
  v_cvt_pk_bf16_f32 v95, v106, v107
  s_setprio 3
  s_add_u32 s3, s69, 71680
  buffer_store_dwordx4 v[92:95], v2, s[32:35], s3 offen sc1
  s_setprio 0
  v_mul_f32 v108, v108, v68
  v_mul_f32 v109, v109, v68
  v_mul_f32 v110, v110, v68
  v_mul_f32 v111, v111, v68
  v_mul_f32 v112, v112, v68
  v_mul_f32 v113, v113, v68
  v_mul_f32 v114, v114, v68
  v_mul_f32 v115, v115, v68
  v_exp_f32 v108, v108
  v_exp_f32 v109, v109
  v_exp_f32 v110, v110
  v_exp_f32 v111, v111
  v_exp_f32 v112, v112
  v_exp_f32 v113, v113
  v_exp_f32 v114, v114
  v_exp_f32 v115, v115
  v_fma_f32 v108, v108, v69, v69
  v_fma_f32 v109, v109, v69, v69
  v_fma_f32 v110, v110, v69, v69
  v_fma_f32 v111, v111, v69, v69
  v_fma_f32 v112, v112, v69, v69
  v_fma_f32 v113, v113, v69, v69
  v_fma_f32 v114, v114, v69, v69
  v_fma_f32 v115, v115, v69, v69
  v_rcp_f32 v108, v108
  v_rcp_f32 v109, v109
  v_rcp_f32 v110, v110
  v_rcp_f32 v111, v111
  v_rcp_f32 v112, v112
  v_rcp_f32 v113, v113
  v_rcp_f32 v114, v114
  v_rcp_f32 v115, v115
  v_mul_f32 v116, v116, v108
  v_mul_f32 v117, v117, v109
  v_mul_f32 v118, v118, v110
  v_mul_f32 v119, v119, v111
  v_mul_f32 v120, v120, v112
  v_mul_f32 v121, v121, v113
  v_mul_f32 v122, v122, v114
  v_mul_f32 v123, v123, v115
  v_cvt_pk_bf16_f32 v108, v116, v117
  v_cvt_pk_bf16_f32 v109, v118, v119
  v_cvt_pk_bf16_f32 v110, v120, v121
  v_cvt_pk_bf16_f32 v111, v122, v123
  s_setprio 3
  s_add_u32 s3, s69, 173056
  buffer_store_dwordx4 v[108:111], v2, s[32:35], s3 offen sc1
  s_setprio 0
  v_mul_f32 v124, v124, v68
  v_mul_f32 v125, v125, v68
  v_mul_f32 v126, v126, v68
  v_mul_f32 v127, v127, v68
  v_mul_f32 v128, v128, v68
  v_mul_f32 v129, v129, v68
  v_mul_f32 v130, v130, v68
  v_mul_f32 v131, v131, v68
  v_exp_f32 v124, v124
  v_exp_f32 v125, v125
  v_exp_f32 v126, v126
  v_exp_f32 v127, v127
  v_exp_f32 v128, v128
  v_exp_f32 v129, v129
  v_exp_f32 v130, v130
  v_exp_f32 v131, v131
  v_fma_f32 v124, v124, v69, v69
  v_fma_f32 v125, v125, v69, v69
  v_fma_f32 v126, v126, v69, v69
  v_fma_f32 v127, v127, v69, v69
  v_fma_f32 v128, v128, v69, v69
  v_fma_f32 v129, v129, v69, v69
  v_fma_f32 v130, v130, v69, v69
  v_fma_f32 v131, v131, v69, v69
  v_rcp_f32 v124, v124
  v_rcp_f32 v125, v125
  v_rcp_f32 v126, v126
  v_rcp_f32 v127, v127
  v_rcp_f32 v128, v128
  v_rcp_f32 v129, v129
  v_rcp_f32 v130, v130
  v_rcp_f32 v131, v131
  v_mul_f32 v132, v132, v124
  v_mul_f32 v133, v133, v125
  v_mul_f32 v134, v134, v126
  v_mul_f32 v135, v135, v127
  v_mul_f32 v136, v136, v128
  v_mul_f32 v137, v137, v129
  v_mul_f32 v138, v138, v130
  v_mul_f32 v139, v139, v131
  v_cvt_pk_bf16_f32 v124, v132, v133
  v_cvt_pk_bf16_f32 v125, v134, v135
  v_cvt_pk_bf16_f32 v126, v136, v137
  v_cvt_pk_bf16_f32 v127, v138, v139
  s_setprio 3
  s_add_u32 s3, s69, 187392
  buffer_store_dwordx4 v[124:127], v2, s[32:35], s3 offen sc1
  s_setprio 0
  v_fmamk_f32 v68, v208, 0x00000000, v209
  v_fmamk_f32 v69, v208, 0x3f800000, v209
  v_fmamk_f32 v70, v208, 0x40000000, v209
  v_fmamk_f32 v71, v208, 0x40400000, v209
  v_sin_f32 v72, v68
  v_sin_f32 v73, v69
  v_sin_f32 v74, v70
  v_sin_f32 v75, v71
  v_cos_f32 v68, v68
  v_cos_f32 v69, v69
  v_cos_f32 v70, v70
  v_cos_f32 v71, v71
  v_cvt_pk_bf16_f32 v142, -v72, -v73
  v_cvt_pk_bf16_f32 v143, -v74, -v75
  v_cvt_pk_bf16_f32 v140, v68, v69
  v_cvt_pk_bf16_f32 v141, v70, v71
  v_fmamk_f32 v68, v208, 0x41000000, v209
  s_setprio 3
  s_waitcnt vmcnt(2)
  s_mov_b64 exec, 0x7f
  buffer_atomic_add v63, v62, s[32:35], 0 offen offset:0 sc1
  s_mov_b64 exec, -1
  s_setprio 0
  s_mov_b32 s13, 0
  s_atomic_add s13, s[22:23], s7 glc
  v_fmamk_f32 v69, v208, 0x41100000, v209
  v_fmamk_f32 v70, v208, 0x41200000, v209
  v_fmamk_f32 v71, v208, 0x41300000, v209
  v_sin_f32 v72, v68
  v_sin_f32 v73, v69
  v_sin_f32 v74, v70
  v_sin_f32 v75, v71
  v_cos_f32 v68, v68
  v_cos_f32 v69, v69
  v_cos_f32 v70, v70
  v_cos_f32 v71, v71
  v_cvt_pk_bf16_f32 v146, -v72, -v73
  v_cvt_pk_bf16_f32 v147, -v74, -v75
  v_cvt_pk_bf16_f32 v144, v68, v69
  v_cvt_pk_bf16_f32 v145, v70, v71
  v_fmamk_f32 v68, v208, 0x41800000, v209
  v_fmamk_f32 v69, v208, 0x41880000, v209
  v_fmamk_f32 v70, v208, 0x41900000, v209
  v_fmamk_f32 v71, v208, 0x41980000, v209
  v_sin_f32 v72, v68
  v_sin_f32 v73, v69
  v_sin_f32 v74, v70
  v_sin_f32 v75, v71
  v_cos_f32 v68, v68
  v_cos_f32 v69, v69
  v_cos_f32 v70, v70
  v_cos_f32 v71, v71
  v_cvt_pk_bf16_f32 v150, -v72, -v73
  v_cvt_pk_bf16_f32 v151, -v74, -v75
  v_cvt_pk_bf16_f32 v148, v68, v69
  v_cvt_pk_bf16_f32 v149, v70, v71
  v_fmamk_f32 v68, v208, 0x41c00000, v209
  v_fmamk_f32 v69, v208, 0x41c80000, v209
  v_fmamk_f32 v70, v208, 0x41d00000, v209
  v_fmamk_f32 v71, v208, 0x41d80000, v209
  v_sin_f32 v72, v68
  v_sin_f32 v73, v69
  v_sin_f32 v74, v70
  v_sin_f32 v75, v71
  v_cos_f32 v68, v68
  v_cos_f32 v69, v69
  v_cos_f32 v70, v70
  v_cos_f32 v71, v71
  v_cvt_pk_bf16_f32 v154, -v72, -v73
  v_cvt_pk_bf16_f32 v155, -v74, -v75
  v_cvt_pk_bf16_f32 v152, v68, v69
  v_cvt_pk_bf16_f32 v153, v70, v71
  v_fmamk_f32 v68, v208, 0x42000000, v209
  v_fmamk_f32 v69, v208, 0x42040000, v209
  v_fmamk_f32 v70, v208, 0x42080000, v209
  v_fmamk_f32 v71, v208, 0x420c0000, v209
  v_sin_f32 v72, v68
  v_sin_f32 v73, v69
  v_sin_f32 v74, v70
  v_sin_f32 v75, v71
  s_setprio 3
  s_waitcnt vmcnt(1)
  s_mov_b64 exec, 0x7f
  buffer_atomic_add v63, v62, s[32:35], 0 offen offset:8 sc1
  s_mov_b64 exec, -1
  s_setprio 0
  v_cos_f32 v68, v68
  v_cos_f32 v69, v69
  v_cos_f32 v70, v70
  v_cos_f32 v71, v71
  v_cvt_pk_bf16_f32 v158, -v72, -v73
  v_cvt_pk_bf16_f32 v159, -v74, -v75
  v_cvt_pk_bf16_f32 v156, v68, v69
  v_cvt_pk_bf16_f32 v157, v70, v71
  v_fmamk_f32 v68, v208, 0x42200000, v209
  v_fmamk_f32 v69, v208, 0x42240000, v209
  v_fmamk_f32 v70, v208, 0x42280000, v209
  v_fmamk_f32 v71, v208, 0x422c0000, v209
  v_sin_f32 v72, v68
  v_sin_f32 v73, v69
  v_sin_f32 v74, v70
  v_sin_f32 v75, v71
  v_cos_f32 v68, v68
  v_cos_f32 v69, v69
  v_cos_f32 v70, v70
  v_cos_f32 v71, v71
  v_cvt_pk_bf16_f32 v162, -v72, -v73
  v_cvt_pk_bf16_f32 v163, -v74, -v75
  v_cvt_pk_bf16_f32 v160, v68, v69
  v_cvt_pk_bf16_f32 v161, v70, v71
  v_fmamk_f32 v68, v208, 0x42400000, v209
  v_fmamk_f32 v69, v208, 0x42440000, v209
  v_fmamk_f32 v70, v208, 0x42480000, v209
  v_fmamk_f32 v71, v208, 0x424c0000, v209
  v_sin_f32 v72, v68
  v_sin_f32 v73, v69
  v_sin_f32 v74, v70
  v_sin_f32 v75, v71
  v_cos_f32 v68, v68
  v_cos_f32 v69, v69
  v_cos_f32 v70, v70
  v_cos_f32 v71, v71
  v_cmp_eq_u32 vcc, 1, v210
  s_nop 1
  v_cndmask_b32 v75, v75, -0.5, vcc
  v_cmp_eq_u32 vcc, 2, v210
  s_nop 1
  v_cndmask_b32 v71, v71, -0.5, vcc
  v_cvt_pk_bf16_f32 v166, -v72, -v73
  v_cvt_pk_bf16_f32 v167, -v74, -v75
  v_cvt_pk_bf16_f32 v164, v68, v69
  v_cvt_pk_bf16_f32 v165, v70, v71
  v_cvt_f32_u32 v6, v10
  v_mul_f32 v6, 0.5, v6
  s_lshl_b32 s56, s52, 1
  s_add_u32 s56, s56, 0
  v_lshl_add_u32 v3, v10, 6, s56
  v_cvt_f32_u32 v3, v3
  v_mul_f32 v3, 0x3a000000, v3
  v_cvt_f32_u32 v4, v9
  v_mul_f32 v4, v4, v3
  v_add_f32 v5, 0x3e800000, v4
  v_fmamk_f32 v68, v3, 0x00000000, v4
  v_fmamk_f32 v69, v3, 0x00000000, v5
  v_fmamk_f32 v70, v3, 0x40000000, v4
  v_fmamk_f32 v71, v3, 0x40000000, v5
  v_fmamk_f32 v72, v3, 0x40800000, v4
  v_fmamk_f32 v73, v3, 0x40800000, v5
  v_fmamk_f32 v74, v3, 0x40c00000, v4
  v_fmamk_f32 v75, v3, 0x40c00000, v5
  v_cmp_eq_u32 vcc, 0, v9
  s_nop 1
  v_cndmask_b32 v69, v69, v6, vcc
  v_cos_f32 v68, v68
  v_cos_f32 v69, v69
  v_cos_f32 v70, v70
  v_cos_f32 v71, v71
  v_cos_f32 v72, v72
  v_cos_f32 v73, v73
  v_cos_f32 v74, v74
  v_cos_f32 v75, v75
  buffer_load_dwordx4 v[248:251], v214, s[24:27], s9 offen offset:0
  buffer_load_dwordx4 v[252:255], v214, s[24:27], s9 offen offset:896
  s_waitcnt lgkmcnt(0)
  s_cmp_ge_u32 s13, 32
  s_cbranch_scc1 L_pf6
  s_mov_b32 s62, 0
L_poll7:
  s_mov_b32 s13, 0
  s_atomic_add s13, s[22:23], s7 glc
  s_add_u32 s62, s62, 1
  s_waitcnt lgkmcnt(0)
  s_cmp_gt_u32 s62, 0x8000
  s_cbranch_scc1 L_pend8
  s_cmp_lt_u32 s13, 32
  s_cbranch_scc1 L_poll7
L_pend8:
L_pf6:
  s_setprio 3
  s_add_u32 s3, s8, 0
  buffer_load_dwordx4 v[12:15], v204, s[32:35], s3 offen offset:0 sc1
  buffer_load_dwordx4 v[16:19], v204, s[32:35], s3 offen offset:1024 sc1
  buffer_load_dwordx4 v[20:23], v204, s[32:35], s3 offen offset:2048 sc1
  buffer_load_dwordx4 v[24:27], v204, s[32:35], s3 offen offset:3072 sc1
  s_add_u32 s3, s8, 4096
  buffer_load_dwordx4 v[28:31], v204, s[32:35], s3 offen offset:0 sc1
  buffer_load_dwordx4 v[32:35], v204, s[32:35], s3 offen offset:1024 sc1
  buffer_load_dwordx4 v[36:39], v204, s[32:35], s3 offen offset:2048 sc1
  buffer_load_dwordx4 v[40:43], v204, s[32:35], s3 offen offset:3072 sc1
  s_setprio 0
  s_add_u32 s7, s7, 4
  v_cvt_pk_bf16_f32 v216, v68, v69
  v_cvt_pk_bf16_f32 v217, v70, v71
  v_cvt_pk_bf16_f32 v218, v72, v73
  s_mov_b32 s13, 0
  s_atomic_add s13, s[22:23], s7 glc
  v_cvt_pk_bf16_f32 v219, v74, v75
  v_fmamk_f32 v68, v3, 0x41000000, v4
  v_fmamk_f32 v69, v3, 0x41000000, v5
  v_fmamk_f32 v70, v3, 0x41200000, v4
  v_fmamk_f32 v71, v3, 0x41200000, v5
  v_fmamk_f32 v72, v3, 0x41400000, v4
  v_fmamk_f32 v73, v3, 0x41400000, v5
  v_fmamk_f32 v74, v3, 0x41600000, v4
  v_fmamk_f32 v75, v3, 0x41600000, v5
  v_cos_f32 v68, v68
  v_cos_f32 v69, v69
  v_cos_f32 v70, v70
  v_cos_f32 v71, v71
  v_cos_f32 v72, v72
  v_cos_f32 v73, v73
  v_cos_f32 v74, v74
  v_cos_f32 v75, v75
  v_cvt_pk_bf16_f32 v220, v68, v69
  v_cvt_pk_bf16_f32 v221, v70, v71
  v_cvt_pk_bf16_f32 v222, v72, v73
  v_cvt_pk_bf16_f32 v223, v74, v75
  s_lshl_b32 s56, s52, 1
  s_add_u32 s56, s56, 1
  v_lshl_add_u32 v3, v10, 6, s56
  v_cvt_f32_u32 v3, v3
  v_mul_f32 v3, 0x3a000000, v3
  v_cvt_f32_u32 v4, v9
  v_mul_f32 v4, v4, v3
  v_add_f32 v5, 0x3e800000, v4
  v_fmamk_f32 v68, v3, 0x00000000, v4
  v_fmamk_f32 v69, v3, 0x00000000, v5
  v_fmamk_f32 v70, v3, 0x40000000, v4
  v_fmamk_f32 v71, v3, 0x40000000, v5
  v_fmamk_f32 v72, v3, 0x40800000, v4
  v_fmamk_f32 v73, v3, 0x40800000, v5
  v_fmamk_f32 v74, v3, 0x40c00000, v4
  v_fmamk_f32 v75, v3, 0x40c00000, v5
  v_cmp_eq_u32 vcc, 0, v9
  s_nop 1
  v_cndmask_b32 v69, v69, v6, vcc
  v_cos_f32 v68, v68
  v_cos_f32 v69, v69
  v_cos_f32 v70, v70
  v_cos_f32 v71, v71
  v_cos_f32 v72, v72
  v_cos_f32 v73, v73
  v_cos_f32 v74, v74
  v_cos_f32 v75, v75
  v_cvt_pk_bf16_f32 v224, v68, v69
  v_cvt_pk_bf16_f32 v225, v70, v71
  v_cvt_pk_bf16_f32 v226, v72, v73
  v_cvt_pk_bf16_f32 v227, v74, v75
  v_fmamk_f32 v68, v3, 0x41000000, v4
  v_fmamk_f32 v69, v3, 0x41000000, v5
  v_fmamk_f32 v70, v3, 0x41200000, v4
  v_fmamk_f32 v71, v3, 0x41200000, v5
  v_fmamk_f32 v72, v3, 0x41400000, v4
  v_fmamk_f32 v73, v3, 0x41400000, v5
  v_fmamk_f32 v74, v3, 0x41600000, v4
  v_fmamk_f32 v75, v3, 0x41600000, v5
  v_cos_f32 v68, v68
  v_cos_f32 v69, v69
  v_cos_f32 v70, v70
  v_cos_f32 v71, v71
  v_cos_f32 v72, v72
  v_cos_f32 v73, v73
  v_cos_f32 v74, v74
  v_cos_f32 v75, v75
  v_cvt_pk_bf16_f32 v228, v68, v69
  v_cvt_pk_bf16_f32 v229, v70, v71
  v_cvt_pk_bf16_f32 v230, v72, v73
  v_cvt_pk_bf16_f32 v231, v74, v75
  v_lshl_add_u32 v3, v9, 1, s55
  v_and_b32 v4, 7, v10
  v_xor_b32 v3, v3, v4
  v_lshlrev_b32 v3, 4, v3
  v_lshl_add_u32 v3, v10, 8, v3
  s_lshl_b32 s56, s54, 14
  v_add_u32 v206, s56, v3
  v_xor_b32 v207, 64, v206
  v_lshrrev_b32 v3, 3, v1
  v_and_b32 v4, 3, v1
  v_lshlrev_b32 v4, 1, v4
  v_xor_b32 v4, v4, v3
  v_lshlrev_b32 v4, 4, v4
  v_lshl_add_u32 v4, v3, 8, v4
  v_bfe_u32 v3, v1, 2, 1
  v_lshl_add_u32 v4, v3, 7, v4
  s_lshl_b32 s56, s49, 11
  v_add_u32 v212, s56, v4
  v_xor_b32 v213, 16, v212
  v_add_u32 v3, 49152, v212
  v_add_u32 v4, 49152, v213
  v_add_u32 v5, 106496, v212
  v_add_u32 v6, 106496, v213
  s_waitcnt lgkmcnt(0)
  s_cmp_ge_u32 s13, 32
  s_cbranch_scc1 L_pf9
  s_mov_b32 s62, 0
L_poll10:
  s_mov_b32 s13, 0
  s_atomic_add s13, s[22:23], s7 glc
  s_add_u32 s62, s62, 1
  s_waitcnt lgkmcnt(0)
  s_cmp_gt_u32 s62, 0x8000
  s_cbranch_scc1 L_pend11
  s_cmp_lt_u32 s13, 32
  s_cbranch_scc1 L_poll10
L_pend11:
L_pf9:
  s_setprio 3
  s_add_u32 s3, s8, 8192
  buffer_load_dwordx4 v[44:47], v204, s[32:35], s3 offen offset:0 sc1
  buffer_load_dwordx4 v[48:51], v204, s[32:35], s3 offen offset:1024 sc1
  buffer_load_dwordx4 v[52:55], v204, s[32:35], s3 offen offset:2048 sc1
  buffer_load_dwordx4 v[56:59], v204, s[32:35], s3 offen offset:3072 sc1
  s_add_u32 s3, s8, 12288
  buffer_load_dwordx4 v[60:63], v204, s[32:35], s3 offen offset:0 sc1
  buffer_load_dwordx4 v[64:67], v204, s[32:35], s3 offen offset:1024 sc1
  s_setprio 0
  v_mov_b32 v8, 1808
  s_mov_b32 s62, 0
L_lw12:
  ds_read_b32 v7, v8
  s_add_u32 s62, s62, 1
  s_cmp_gt_u32 s62, 0x40000
  s_cbranch_scc1 L_lwe13
  s_waitcnt lgkmcnt(0)
  v_cmp_gt_u32 vcc, 4, v7
  s_cbranch_vccnz L_lw12
L_lwe13:
  s_waitcnt lgkmcnt(0)
  s_waitcnt vmcnt(15)
  v_lshlrev_b32 v172, 16, v248
  v_and_b32 v173, 0xffff0000, v248
  v_lshlrev_b32 v174, 16, v249
  v_and_b32 v175, 0xffff0000, v249
  v_lshlrev_b32 v176, 16, v250
  v_and_b32 v177, 0xffff0000, v250
  v_lshlrev_b32 v178, 16, v251
  v_and_b32 v179, 0xffff0000, v251
  s_waitcnt vmcnt(14)
  v_lshlrev_b32 v180, 16, v252
  v_and_b32 v181, 0xffff0000, v252
  v_lshlrev_b32 v182, 16, v253
  v_and_b32 v183, 0xffff0000, v253
  v_lshlrev_b32 v184, 16, v254
  v_and_b32 v185, 0xffff0000, v254
  v_lshlrev_b32 v186, 16, v255
  v_and_b32 v187, 0xffff0000, v255
  s_setprio 3
  s_waitcnt vmcnt(13)
  v_mfma_f32_32x32x16_bf16 v[76:91], v[12:15], v[140:143], 0
  s_waitcnt vmcnt(12)
  v_mfma_f32_32x32x16_bf16 v[92:107], v[16:19], v[140:143], 0
  s_waitcnt vmcnt(11)
  v_mfma_f32_32x32x16_bf16 v[76:91], v[20:23], v[144:147], v[76:91]
  s_waitcnt vmcnt(10)
  v_mfma_f32_32x32x16_bf16 v[92:107], v[24:27], v[144:147], v[92:107]
  s_waitcnt vmcnt(9)
  v_mfma_f32_32x32x16_bf16 v[76:91], v[28:31], v[148:151], v[76:91]
  s_waitcnt vmcnt(8)
  v_mfma_f32_32x32x16_bf16 v[92:107], v[32:35], v[148:151], v[92:107]
  s_waitcnt vmcnt(7)
  v_mfma_f32_32x32x16_bf16 v[76:91], v[36:39], v[152:155], v[76:91]
  s_waitcnt vmcnt(6)
  v_mfma_f32_32x32x16_bf16 v[92:107], v[40:43], v[152:155], v[92:107]
  s_waitcnt vmcnt(5)
  v_mfma_f32_32x32x16_bf16 v[76:91], v[44:47], v[156:159], v[76:91]
  s_waitcnt vmcnt(4)
  v_mfma_f32_32x32x16_bf16 v[92:107], v[48:51], v[156:159], v[92:107]
  s_waitcnt vmcnt(3)
  v_mfma_f32_32x32x16_bf16 v[76:91], v[52:55], v[160:163], v[76:91]
  s_waitcnt vmcnt(2)
  v_mfma_f32_32x32x16_bf16 v[92:107], v[56:59], v[160:163], v[92:107]
  s_waitcnt vmcnt(1)
  v_mfma_f32_32x32x16_bf16 v[76:91], v[60:63], v[164:167], v[76:91]
  s_waitcnt vmcnt(0)
  v_mfma_f32_32x32x16_bf16 v[92:107], v[64:67], v[164:167], v[92:107]
  s_nop 9
  v_cvt_pk_bf16_f32 v188, v76, v77
  v_cvt_pk_bf16_f32 v189, v80, v81
  v_cvt_pk_bf16_f32 v190, v84, v85
  v_cvt_pk_bf16_f32 v191, v88, v89
  s_nop 1
  v_mfma_f32_32x32x16_bf16 v[108:123], v[188:191], v[216:219], 0
  v_cvt_pk_bf16_f32 v196, v78, v79
  v_cvt_pk_bf16_f32 v197, v82, v83
  v_cvt_pk_bf16_f32 v198, v86, v87
  v_cvt_pk_bf16_f32 v199, v90, v91
  s_nop 1
  v_mfma_f32_32x32x16_bf16 v[124:139], v[196:199], v[224:227], 0
  v_cvt_pk_bf16_f32 v192, v92, v93
  v_cvt_pk_bf16_f32 v193, v96, v97
  v_cvt_pk_bf16_f32 v194, v100, v101
  v_cvt_pk_bf16_f32 v195, v104, v105
  s_nop 1
  v_mfma_f32_32x32x16_bf16 v[108:123], v[192:195], v[220:223], v[108:123]
  v_cvt_pk_bf16_f32 v200, v94, v95
  v_cvt_pk_bf16_f32 v201, v98, v99
  v_cvt_pk_bf16_f32 v202, v102, v103
  v_cvt_pk_bf16_f32 v203, v106, v107
  s_nop 1
  v_mfma_f32_32x32x16_bf16 v[124:139], v[200:203], v[228:231], v[124:139]
  s_nop 4
  ds_write_b128 v206, v[108:111] offset:8192
  ds_write_b128 v207, v[112:115] offset:8192
  ds_write_b128 v206, v[116:119] offset:8320
  ds_write_b128 v207, v[120:123] offset:8320
  s_nop 2
  ds_write_b128 v206, v[124:127] offset:16384
  ds_write_b128 v207, v[128:131] offset:16384
  ds_write_b128 v206, v[132:135] offset:16512
  ds_write_b128 v207, v[136:139] offset:16512
  v_mov_b32 v8, 1796
  v_mov_b32 v7, 1
  s_mov_b64 exec, 1
  ds_add_u32 v8, v7
  s_mov_b64 exec, -1
  s_setprio 1
  v_mov_b32 v8, 1796
  s_mov_b32 s62, 0
L_lw14:
  ds_read_b32 v7, v8
  s_add_u32 s62, s62, 1
  s_cmp_gt_u32 s62, 0x40000
  s_cbranch_scc1 L_lwe15
  s_waitcnt lgkmcnt(0)
  v_cmp_gt_u32 vcc, 4, v7
  s_cbranch_vccnz L_lw14
L_lwe15:
  s_waitcnt lgkmcnt(0)
  ds_read_b128 v[76:79], v212 offset:8192
  ds_read_b128 v[80:83], v213 offset:8192
  ds_read_b128 v[84:87], v212 offset:24576
  ds_read_b128 v[88:91], v213 offset:24576
  ds_read_b128 v[92:95], v212 offset:16384
  ds_read_b128 v[96:99], v213 offset:16384
  ds_read_b128 v[100:103], v212 offset:32768
  ds_read_b128 v[104:107], v213 offset:32768
  s_waitcnt lgkmcnt(5)
  v_add_f32 v232, v76, v84
  s_waitcnt lgkmcnt(4)
  v_add_f32 v233, v80, v88
  v_add_f32 v234, v77, v85
  v_add_f32 v235, v81, v89
  v_add_f32 v236, v78, v86
  v_add_f32 v237, v82, v90
  v_add_f32 v238, v79, v87
  v_add_f32 v239, v83, v91
  s_waitcnt lgkmcnt(1)
  v_add_f32 v240, v92, v100
  s_waitcnt lgkmcnt(0)
  v_add_f32 v241, v96, v104
  v_add_f32 v242, v93, v101
  v_add_f32 v243, v97, v105
  v_add_f32 v244, v94, v102
  v_add_f32 v245, v98, v106
  v_add_f32 v246, v95, v103
  v_add_f32 v247, v99, v107
  v_mov_b32 v8, 1800
  s_mov_b32 s62, 0
L_lw16:
  ds_read_b32 v7, v8
  s_add_u32 s62, s62, 1
  s_cmp_gt_u32 s62, 0x40000
  s_cbranch_scc1 L_lwe17
  s_waitcnt lgkmcnt(0)
  v_cmp_gt_u32 vcc, 4, v7
  s_cbranch_vccnz L_lw16
L_lwe17:
  s_waitcnt lgkmcnt(0)
  ds_read_b128 v[12:15], v3 offset:0
  ds_read_b128 v[16:19], v4 offset:0
  ds_read_b128 v[20:23], v3 offset:28672
  ds_read_b128 v[24:27], v4 offset:28672
  ds_read_b128 v[28:31], v5 offset:0
  ds_read_b128 v[32:35], v6 offset:0
  ds_read_b128 v[36:39], v5 offset:28672
  ds_read_b128 v[40:43], v6 offset:28672
  s_waitcnt lgkmcnt(5)
  v_add_f32 v12, v12, v20
  v_add_f32 v13, v13, v21
  v_add_f32 v14, v14, v22
  v_add_f32 v15, v15, v23
  s_waitcnt lgkmcnt(4)
  v_add_f32 v16, v16, v24
  v_add_f32 v17, v17, v25
  v_add_f32 v18, v18, v26
  v_add_f32 v19, v19, v27
  s_waitcnt lgkmcnt(3)
  v_add_f32 v12, v12, v28
  v_add_f32 v13, v13, v29
  v_add_f32 v14, v14, v30
  v_add_f32 v15, v15, v31
  s_waitcnt lgkmcnt(2)
  v_add_f32 v16, v16, v32
  v_add_f32 v17, v17, v33
  v_add_f32 v18, v18, v34
  v_add_f32 v19, v19, v35
  s_waitcnt lgkmcnt(1)
  v_add_f32 v12, v12, v36
  v_add_f32 v13, v13, v37
  v_add_f32 v14, v14, v38
  v_add_f32 v15, v15, v39
  s_waitcnt lgkmcnt(0)
  v_add_f32 v16, v16, v40
  v_add_f32 v17, v17, v41
  v_add_f32 v18, v18, v42
  v_add_f32 v19, v19, v43
  v_mul_f32 v20, 0xbfb8aa3b, v12
  v_mul_f32 v21, 0xbfb8aa3b, v13
  v_mul_f32 v22, 0xbfb8aa3b, v14
  v_mul_f32 v23, 0xbfb8aa3b, v15
  v_mul_f32 v24, 0xbfb8aa3b, v16
  v_mul_f32 v25, 0xbfb8aa3b, v17
  v_mul_f32 v26, 0xbfb8aa3b, v18
  v_mul_f32 v27, 0xbfb8aa3b, v19
  v_exp_f32 v20, v20
  v_exp_f32 v21, v21
  v_exp_f32 v22, v22
  v_exp_f32 v23, v23
  v_exp_f32 v24, v24
  v_exp_f32 v25, v25
  v_exp_f32 v26, v26
  v_exp_f32 v27, v27
  v_mul_f32 v12, v12, v232
  v_mul_f32 v13, v13, v233
  v_mul_f32 v14, v14, v234
  v_mul_f32 v15, v15, v235
  v_mul_f32 v16, v16, v236
  v_mul_f32 v17, v17, v237
  v_mul_f32 v18, v18, v238
  v_mul_f32 v19, v19, v239
  v_add_f32 v20, 1.0, v20
  v_add_f32 v21, 1.0, v21
  v_add_f32 v22, 1.0, v22
  v_add_f32 v23, 1.0, v23
  v_add_f32 v24, 1.0, v24
  v_add_f32 v25, 1.0, v25
  v_add_f32 v26, 1.0, v26
  v_add_f32 v27, 1.0, v27
  v_rcp_f32 v20, v20
  v_rcp_f32 v21, v21
  v_rcp_f32 v22, v22
  v_rcp_f32 v23, v23
  v_rcp_f32 v24, v24
  v_rcp_f32 v25, v25
  v_rcp_f32 v26, v26
  v_rcp_f32 v27, v27
  v_fma_f32 v12, v12, v20, v172
  v_fma_f32 v13, v13, v21, v173
  v_fma_f32 v14, v14, v22, v174
  v_fma_f32 v15, v15, v23, v175
  v_fma_f32 v16, v16, v24, v176
  v_fma_f32 v17, v17, v25, v177
  v_fma_f32 v18, v18, v26, v178
  v_fma_f32 v19, v19, v27, v179
  v_cvt_pk_bf16_f32 v116, v12, v13
  v_cvt_pk_bf16_f32 v117, v14, v15
  v_cvt_pk_bf16_f32 v118, v16, v17
  v_cvt_pk_bf16_f32 v119, v18, v19
  buffer_store_dwordx4 v[116:119], v214, s[40:43], s9 offen offset:0
  s_barrier
  ds_read_b128 v[12:15], v3 offset:8192
  ds_read_b128 v[16:19], v4 offset:8192
  ds_read_b128 v[20:23], v3 offset:36864
  ds_read_b128 v[24:27], v4 offset:36864
  ds_read_b128 v[28:31], v5 offset:8192
  ds_read_b128 v[32:35], v6 offset:8192
  ds_read_b128 v[36:39], v5 offset:36864
  ds_read_b128 v[40:43], v6 offset:36864
  s_waitcnt lgkmcnt(5)
  v_pk_add_f32 v[12:13], v[12:13], v[20:21]
  v_pk_add_f32 v[14:15], v[14:15], v[22:23]
  s_waitcnt lgkmcnt(4)
  v_pk_add_f32 v[16:17], v[16:17], v[24:25]
  v_pk_add_f32 v[18:19], v[18:19], v[26:27]
  s_waitcnt lgkmcnt(3)
  v_pk_add_f32 v[12:13], v[12:13], v[28:29]
  v_pk_add_f32 v[14:15], v[14:15], v[30:31]
  s_waitcnt lgkmcnt(2)
  v_pk_add_f32 v[16:17], v[16:17], v[32:33]
  v_pk_add_f32 v[18:19], v[18:19], v[34:35]
  s_waitcnt lgkmcnt(1)
  v_pk_add_f32 v[12:13], v[12:13], v[36:37]
  v_pk_add_f32 v[14:15], v[14:15], v[38:39]
  s_waitcnt lgkmcnt(0)
  v_pk_add_f32 v[16:17], v[16:17], v[40:41]
  v_pk_add_f32 v[18:19], v[18:19], v[42:43]
  v_mul_f32 v20, 0xbfb8aa3b, v12
  v_mul_f32 v21, 0xbfb8aa3b, v13
  v_mul_f32 v22, 0xbfb8aa3b, v14
  v_mul_f32 v23, 0xbfb8aa3b, v15
  v_mul_f32 v24, 0xbfb8aa3b, v16
  v_mul_f32 v25, 0xbfb8aa3b, v17
  v_mul_f32 v26, 0xbfb8aa3b, v18
  v_mul_f32 v27, 0xbfb8aa3b, v19
  v_exp_f32 v20, v20
  v_exp_f32 v21, v21
  v_exp_f32 v22, v22
  v_exp_f32 v23, v23
  v_exp_f32 v24, v24
  v_exp_f32 v25, v25
  v_exp_f32 v26, v26
  v_exp_f32 v27, v27
  v_pk_mul_f32 v[12:13], v[12:13], v[240:241]
  v_pk_mul_f32 v[14:15], v[14:15], v[242:243]
  v_pk_mul_f32 v[16:17], v[16:17], v[244:245]
  v_pk_mul_f32 v[18:19], v[18:19], v[246:247]
  v_add_f32 v20, 1.0, v20
  v_add_f32 v21, 1.0, v21
  v_add_f32 v22, 1.0, v22
  v_add_f32 v23, 1.0, v23
  v_add_f32 v24, 1.0, v24
  v_add_f32 v25, 1.0, v25
  v_add_f32 v26, 1.0, v26
  v_add_f32 v27, 1.0, v27
  v_rcp_f32 v20, v20
  v_rcp_f32 v21, v21
  v_rcp_f32 v22, v22
  v_rcp_f32 v23, v23
  v_rcp_f32 v24, v24
  v_rcp_f32 v25, v25
  v_rcp_f32 v26, v26
  v_rcp_f32 v27, v27
  v_pk_fma_f32 v[12:13], v[12:13], v[20:21], v[180:181]
  v_pk_fma_f32 v[14:15], v[14:15], v[22:23], v[182:183]
  v_pk_fma_f32 v[16:17], v[16:17], v[24:25], v[184:185]
  v_pk_fma_f32 v[18:19], v[18:19], v[26:27], v[186:187]
  v_cvt_pk_bf16_f32 v120, v12, v13
  v_cvt_pk_bf16_f32 v121, v14, v15
  v_cvt_pk_bf16_f32 v122, v16, v17
  v_cvt_pk_bf16_f32 v123, v18, v19
  buffer_store_dwordx4 v[120:123], v214, s[40:43], s9 offen offset:896
  s_endpgm
L_A1:
  s_waitcnt vmcnt(12)
  s_barrier
  s_add_u32 m0, s60, 32768
  s_add_u32 s61, s61, 57344
  s_cmp_ge_u32 s61, s14
  s_cselect_b32 s15, 1605632, 0
  s_sub_u32 s61, s61, s15
  buffer_load_dwordx4 v58, s[28:31], s61 offen lds
  s_add_u32 m0, s60, 36864
  s_add_u32 s61, s61, 57344
  buffer_load_dwordx4 v58, s[28:31], s61 offen lds
  s_add_u32 s3, s68, 286720
  buffer_load_dwordx4 v[160:163], v59, s[36:39], s3 offen
  s_add_u32 s3, s68, 293888
  buffer_load_dwordx4 v[164:167], v59, s[36:39], s3 offen
  s_add_u32 s3, s68, 401408
  buffer_load_dwordx4 v[168:171], v59, s[36:39], s3 offen
  s_add_u32 s3, s68, 408576
  buffer_load_dwordx4 v[172:175], v59, s[36:39], s3 offen
  s_setprio 0
  s_waitcnt vmcnt(16)
  s_barrier
  ds_read_b64_tr_b16 v[28:29], v56 offset:0
  ds_read_b64_tr_b16 v[30:31], v56 offset:512
  ds_read_b128 v[12:15], v52 offset:0
  ds_read_b64_tr_b16 v[32:33], v57 offset:0
  ds_read_b64_tr_b16 v[34:35], v57 offset:512
  ds_read_b128 v[16:19], v52 offset:28672
  s_add_u32 s3, s68, 516096
  buffer_load_dwordx4 v[176:179], v59, s[36:39], s3 offen
  ds_read_b64_tr_b16 v[36:37], v56 offset:4096
  ds_read_b64_tr_b16 v[38:39], v56 offset:4608
  ds_read_b64_tr_b16 v[40:41], v57 offset:4096
  ds_read_b64_tr_b16 v[42:43], v57 offset:4608
  s_add_u32 s3, s68, 523264
  buffer_load_dwordx4 v[180:183], v59, s[36:39], s3 offen
  s_waitcnt lgkmcnt(7)
  v_mfma_f32_32x32x16_bf16 v[76:91], v[28:31], v[12:15], 0
  ds_read_b128 v[20:23], v53 offset:0
  s_waitcnt lgkmcnt(6)
  v_mfma_f32_32x32x16_bf16 v[92:107], v[32:35], v[12:15], 0
  ds_read_b128 v[24:27], v53 offset:28672
  s_waitcnt lgkmcnt(6)
  v_mfma_f32_32x32x16_bf16 v[108:123], v[28:31], v[16:19], 0
  v_mfma_f32_32x32x16_bf16 v[124:139], v[32:35], v[16:19], 0
  s_waitcnt vmcnt(16) lgkmcnt(2)
  s_barrier
  s_waitcnt lgkmcnt(1)
  v_mfma_f32_32x32x16_bf16 v[76:91], v[36:39], v[20:23], v[76:91]
  ds_read_b64_tr_b16 v[44:45], v56 offset:8192
  ds_read_b64_tr_b16 v[46:47], v56 offset:8704
  ds_read_b128 v[12:15], v54 offset:0
  s_add_u32 s3, s68, 630784
  buffer_load_dwordx4 v[184:187], v59, s[36:39], s3 offen
  v_mfma_f32_32x32x16_bf16 v[92:107], v[40:43], v[20:23], v[92:107]
  ds_read_b64_tr_b16 v[48:49], v57 offset:8192
  ds_read_b64_tr_b16 v[50:51], v57 offset:8704
  ds_read_b128 v[16:19], v54 offset:28672
  s_waitcnt lgkmcnt(6)
  v_mfma_f32_32x32x16_bf16 v[108:123], v[36:39], v[24:27], v[108:123]
  ds_read_b64_tr_b16 v[28:29], v56 offset:12288
  ds_read_b64_tr_b16 v[30:31], v56 offset:12800
  s_add_u32 s3, s68, 637952
  buffer_load_dwordx4 v[188:191], v59, s[36:39], s3 offen
  v_mfma_f32_32x32x16_bf16 v[124:139], v[40:43], v[24:27], v[124:139]
  ds_read_b64_tr_b16 v[32:33], v57 offset:12288
  ds_read_b64_tr_b16 v[34:35], v57 offset:12800
  s_lshl_b32 s56, s55, 12
  v_lshl_add_u32 v60, v1, 2, s56
  s_waitcnt lgkmcnt(7)
  v_mfma_f32_32x32x16_bf16 v[76:91], v[44:47], v[12:15], v[76:91]
  ds_read_b128 v[20:23], v55 offset:0
  s_add_u32 m0, s60, 0
  s_add_u32 s61, s61, 57344
  buffer_load_dwordx4 v58, s[28:31], s61 offen lds
  s_waitcnt lgkmcnt(6)
  v_mfma_f32_32x32x16_bf16 v[92:107], v[48:51], v[12:15], v[92:107]
  ds_read_b128 v[24:27], v55 offset:28672
  s_lshl_b32 s56, s54, 12
  s_add_u32 s56, s56, 1024
  s_waitcnt lgkmcnt(6)
  v_mfma_f32_32x32x16_bf16 v[108:123], v[44:47], v[16:19], v[108:123]
  s_add_u32 m0, s60, 4096
  s_add_u32 s61, s61, 57344
  buffer_load_dwordx4 v58, s[28:31], s61 offen lds
  v_lshl_add_u32 v61, v10, 4, s56
  v_mfma_f32_32x32x16_bf16 v[124:139], v[48:51], v[16:19], v[124:139]
  s_waitcnt vmcnt(18) lgkmcnt(2)
  s_barrier
  s_waitcnt lgkmcnt(1)
  v_mfma_f32_32x32x16_bf16 v[76:91], v[28:31], v[20:23], v[76:91]
  ds_read_b64_tr_b16 v[36:37], v56 offset:16384
  ds_read_b64_tr_b16 v[38:39], v56 offset:16896
  ds_read_b128 v[12:15], v52 offset:4096
  s_add_u32 s3, s68, 745472
  buffer_load_dwordx4 v[192:195], v59, s[36:39], s3 offen
  v_mfma_f32_32x32x16_bf16 v[92:107], v[32:35], v[20:23], v[92:107]
  ds_read_b64_tr_b16 v[40:41], v57 offset:16384
  ds_read_b64_tr_b16 v[42:43], v57 offset:16896
  ds_read_b128 v[16:19], v52 offset:32768
  s_waitcnt lgkmcnt(6)
  v_mfma_f32_32x32x16_bf16 v[108:123], v[28:31], v[24:27], v[108:123]
  ds_read_b64_tr_b16 v[44:45], v56 offset:20480
  ds_read_b64_tr_b16 v[46:47], v56 offset:20992
  s_add_u32 s3, s68, 752640
  buffer_load_dwordx4 v[196:199], v59, s[36:39], s3 offen
  v_mfma_f32_32x32x16_bf16 v[124:139], v[32:35], v[24:27], v[124:139]
  ds_read_b64_tr_b16 v[48:49], v57 offset:20480
  ds_read_b64_tr_b16 v[50:51], v57 offset:20992
  s_lshl_b32 s56, s50, 1
  s_add_u32 s56, s56, s54
  s_mul_i32 s69, s56, 231424
  s_waitcnt lgkmcnt(7)
  v_mfma_f32_32x32x16_bf16 v[76:91], v[36:39], v[12:15], v[76:91]
  ds_read_b128 v[20:23], v53 offset:4096
  s_add_u32 m0, s60, 8192
  s_add_u32 s61, s61, 57344
  s_cmp_ge_u32 s61, s14
  s_cselect_b32 s15, 1605632, 0
  s_sub_u32 s61, s61, s15
  buffer_load_dwordx4 v58, s[28:31], s61 offen lds
  s_waitcnt lgkmcnt(6)
  v_mfma_f32_32x32x16_bf16 v[92:107], v[40:43], v[12:15], v[92:107]
  ds_read_b128 v[24:27], v53 offset:32768
  s_mul_i32 s57, s55, 28
  s_add_u32 s57, s57, s51
  s_waitcnt lgkmcnt(6)
  v_mfma_f32_32x32x16_bf16 v[108:123], v[36:39], v[16:19], v[108:123]
  s_add_u32 m0, s60, 12288
  s_add_u32 s61, s61, 57344
  buffer_load_dwordx4 v58, s[28:31], s61 offen lds
  s_lshl_b32 s57, s57, 10
  s_add_u32 s69, s69, s57
  v_mfma_f32_32x32x16_bf16 v[124:139], v[40:43], v[16:19], v[124:139]
  s_waitcnt vmcnt(20) lgkmcnt(2)
  s_barrier
  s_waitcnt lgkmcnt(1)
  v_mfma_f32_32x32x16_bf16 v[76:91], v[44:47], v[20:23], v[76:91]
  ds_read_b64_tr_b16 v[28:29], v56 offset:24576
  ds_read_b64_tr_b16 v[30:31], v56 offset:25088
  ds_read_b128 v[12:15], v54 offset:4096
  s_add_u32 m0, s60, 16384
  s_add_u32 s61, s61, 57344
  buffer_load_dwordx4 v58, s[28:31], s61 offen lds
  v_mfma_f32_32x32x16_bf16 v[92:107], v[48:51], v[20:23], v[92:107]
  ds_read_b64_tr_b16 v[32:33], v57 offset:24576
  ds_read_b64_tr_b16 v[34:35], v57 offset:25088
  ds_read_b128 v[16:19], v54 offset:32768
  s_waitcnt lgkmcnt(6)
  v_mfma_f32_32x32x16_bf16 v[108:123], v[44:47], v[24:27], v[108:123]
  ds_read_b64_tr_b16 v[36:37], v56 offset:28672
  ds_read_b64_tr_b16 v[38:39], v56 offset:29184
  s_add_u32 m0, s60, 20480
  s_add_u32 s61, s61, 57344
  buffer_load_dwordx4 v58, s[28:31], s61 offen lds
  v_mfma_f32_32x32x16_bf16 v[124:139], v[48:51], v[24:27], v[124:139]
  ds_read_b64_tr_b16 v[40:41], v57 offset:28672
  ds_read_b64_tr_b16 v[42:43], v57 offset:29184
  s_mul_i32 s56, s56, 896
  s_lshl_b32 s57, s55, 2
  s_add_u32 s56, s56, s57
  s_waitcnt lgkmcnt(7)
  v_mfma_f32_32x32x16_bf16 v[76:91], v[28:31], v[12:15], v[76:91]
  ds_read_b128 v[20:23], v55 offset:4096
  s_waitcnt lgkmcnt(6)
  v_mfma_f32_32x32x16_bf16 v[92:107], v[32:35], v[12:15], v[92:107]
  ds_read_b128 v[24:27], v55 offset:32768
  s_add_u32 s56, s56, 11141120
  s_waitcnt lgkmcnt(6)
  v_mfma_f32_32x32x16_bf16 v[108:123], v[28:31], v[16:19], v[108:123]
  v_mov_b32 v63, 1
  v_mfma_f32_32x32x16_bf16 v[124:139], v[32:35], v[16:19], v[124:139]
  s_waitcnt vmcnt(16) lgkmcnt(2)
  s_barrier
  s_waitcnt lgkmcnt(1)
  v_mfma_f32_32x32x16_bf16 v[76:91], v[36:39], v[20:23], v[76:91]
  ds_read_b64_tr_b16 v[44:45], v56 offset:32768
  ds_read_b64_tr_b16 v[46:47], v56 offset:33280
  ds_read_b128 v[12:15], v52 offset:8192
  s_add_u32 s3, s68, 71680
  buffer_load_dwordx4 v[200:203], v59, s[36:39], s3 offen
  v_mfma_f32_32x32x16_bf16 v[92:107], v[40:43], v[20:23], v[92:107]
  ds_read_b64_tr_b16 v[48:49], v57 offset:32768
  ds_read_b64_tr_b16 v[50:51], v57 offset:33280
  ds_read_b128 v[16:19], v52 offset:36864
  s_waitcnt lgkmcnt(6)
  v_mfma_f32_32x32x16_bf16 v[108:123], v[36:39], v[24:27], v[108:123]
  ds_read_b64_tr_b16 v[28:29], v56 offset:36864
  ds_read_b64_tr_b16 v[30:31], v56 offset:37376
  s_add_u32 s3, s68, 78848
  buffer_load_dwordx4 v[204:207], v59, s[36:39], s3 offen
  v_mfma_f32_32x32x16_bf16 v[124:139], v[40:43], v[24:27], v[124:139]
  ds_read_b64_tr_b16 v[32:33], v57 offset:36864
  ds_read_b64_tr_b16 v[34:35], v57 offset:37376
  v_lshl_add_u32 v62, v1, 7, s56
  s_mul_i32 s56, s52, 7
  s_waitcnt lgkmcnt(7)
  v_mfma_f32_32x32x16_bf16 v[76:91], v[44:47], v[12:15], v[76:91]
  ds_read_b128 v[20:23], v53 offset:8192
  s_add_u32 m0, s60, 24576
  s_add_u32 s61, s61, 57344
  s_cmp_ge_u32 s61, s14
  s_cselect_b32 s15, 1605632, 0
  s_sub_u32 s61, s61, s15
  buffer_load_dwordx4 v58, s[28:31], s61 offen lds
  s_waitcnt lgkmcnt(6)
  v_mfma_f32_32x32x16_bf16 v[92:107], v[48:51], v[12:15], v[92:107]
  ds_read_b128 v[24:27], v53 offset:36864
  s_add_u32 s56, s56, s53
  s_lshl_b32 s56, s56, 7
  s_waitcnt lgkmcnt(6)
  v_mfma_f32_32x32x16_bf16 v[108:123], v[44:47], v[16:19], v[108:123]
  s_add_u32 m0, s60, 28672
  s_add_u32 s61, s61, 57344
  buffer_load_dwordx4 v58, s[28:31], s61 offen lds
  s_lshl_b32 s57, s54, 2
  s_add_u32 s56, s56, s57
  v_mfma_f32_32x32x16_bf16 v[124:139], v[48:51], v[16:19], v[124:139]
  s_waitcnt vmcnt(10) lgkmcnt(2)
  s_barrier
  s_waitcnt lgkmcnt(1)
  v_mfma_f32_32x32x16_bf16 v[76:91], v[28:31], v[20:23], v[76:91]
  ds_read_b64_tr_b16 v[36:37], v56 offset:0
  ds_read_b64_tr_b16 v[38:39], v56 offset:512
  ds_read_b128 v[12:15], v54 offset:8192
  s_add_u32 s3, s68, 186368
  buffer_load_dwordx4 v[208:211], v59, s[36:39], s3 offen
  v_mfma_f32_32x32x16_bf16 v[92:107], v[32:35], v[20:23], v[92:107]
  ds_read_b64_tr_b16 v[40:41], v57 offset:0
  ds_read_b64_tr_b16 v[42:43], v57 offset:512
  ds_read_b128 v[16:19], v54 offset:36864
  s_waitcnt lgkmcnt(6)
  v_mfma_f32_32x32x16_bf16 v[108:123], v[28:31], v[24:27], v[108:123]
  ds_read_b64_tr_b16 v[44:45], v56 offset:4096
  ds_read_b64_tr_b16 v[46:47], v56 offset:4608
  s_add_u32 s3, s68, 193536
  buffer_load_dwordx4 v[212:215], v59, s[36:39], s3 offen
  v_mfma_f32_32x32x16_bf16 v[124:139], v[32:35], v[24:27], v[124:139]
  ds_read_b64_tr_b16 v[48:49], v57 offset:4096
  ds_read_b64_tr_b16 v[50:51], v57 offset:4608
  s_add_u32 s6, s56, 11141120
  s_mul_i32 s66, s52, 231424
  s_mul_i32 s57, s54, 28672
  s_waitcnt lgkmcnt(7)
  v_mfma_f32_32x32x16_bf16 v[76:91], v[36:39], v[12:15], v[76:91]
  ds_read_b128 v[20:23], v55 offset:8192
  s_add_u32 m0, s60, 32768
  s_add_u32 s61, s61, 57344
  buffer_load_dwordx4 v58, s[28:31], s61 offen lds
  s_waitcnt lgkmcnt(6)
  v_mfma_f32_32x32x16_bf16 v[92:107], v[40:43], v[12:15], v[92:107]
  ds_read_b128 v[24:27], v55 offset:36864
  s_add_u32 s66, s66, s57
  s_mul_i32 s57, s55, 7168
  s_waitcnt lgkmcnt(6)
  v_mfma_f32_32x32x16_bf16 v[108:123], v[36:39], v[16:19], v[108:123]
  s_add_u32 m0, s60, 36864
  s_add_u32 s61, s61, 57344
  buffer_load_dwordx4 v58, s[28:31], s61 offen lds
  s_add_u32 s66, s66, s57
  s_mul_i32 s10, s49, 28672
  v_mfma_f32_32x32x16_bf16 v[124:139], v[40:43], v[16:19], v[124:139]
  s_waitcnt vmcnt(10) lgkmcnt(2)
  s_barrier
  s_waitcnt lgkmcnt(1)
  v_mfma_f32_32x32x16_bf16 v[76:91], v[44:47], v[20:23], v[76:91]
  ds_read_b64_tr_b16 v[28:29], v56 offset:8192
  ds_read_b64_tr_b16 v[30:31], v56 offset:8704
  ds_read_b128 v[12:15], v52 offset:12288
  s_add_u32 s3, s68, 301056
  buffer_load_dwordx4 v[216:219], v59, s[36:39], s3 offen
  v_mfma_f32_32x32x16_bf16 v[92:107], v[48:51], v[20:23], v[92:107]
  ds_read_b64_tr_b16 v[32:33], v57 offset:8192
  ds_read_b64_tr_b16 v[34:35], v57 offset:8704
  ds_read_b128 v[16:19], v52 offset:40960
  s_waitcnt lgkmcnt(6)
  v_mfma_f32_32x32x16_bf16 v[108:123], v[44:47], v[24:27], v[108:123]
  ds_read_b64_tr_b16 v[36:37], v56 offset:12288
  ds_read_b64_tr_b16 v[38:39], v56 offset:12800
  s_add_u32 s3, s68, 308224
  buffer_load_dwordx4 v[220:223], v59, s[36:39], s3 offen
  v_mfma_f32_32x32x16_bf16 v[124:139], v[48:51], v[24:27], v[124:139]
  ds_read_b64_tr_b16 v[40:41], v57 offset:12288
  ds_read_b64_tr_b16 v[42:43], v57 offset:12800
  s_add_u32 s10, s10, 49152
  s_mul_i32 s11, s49, 10240
  s_add_u32 s11, s11, 8192
  s_waitcnt lgkmcnt(7)
  v_mfma_f32_32x32x16_bf16 v[76:91], v[28:31], v[12:15], v[76:91]
  ds_read_b128 v[20:23], v53 offset:12288
  s_add_u32 m0, s60, 0
  s_add_u32 s61, s61, 57344
  s_cmp_ge_u32 s61, s14
  s_cselect_b32 s15, 1605632, 0
  s_sub_u32 s61, s61, s15
  buffer_load_dwordx4 v58, s[28:31], s61 offen lds
  s_waitcnt lgkmcnt(6)
  v_mfma_f32_32x32x16_bf16 v[92:107], v[32:35], v[12:15], v[92:107]
  ds_read_b128 v[24:27], v53 offset:40960
  s_lshl_b32 s56, s51, 3
  s_add_u32 s56, s56, s49
  s_waitcnt lgkmcnt(6)
  v_mfma_f32_32x32x16_bf16 v[108:123], v[28:31], v[16:19], v[108:123]
  s_add_u32 m0, s60, 4096
  s_add_u32 s61, s61, 57344
  buffer_load_dwordx4 v58, s[28:31], s61 offen lds
  s_lshl_b32 s56, s56, 11
  s_add_u32 s40, s56, 11239424
  v_mfma_f32_32x32x16_bf16 v[124:139], v[32:35], v[16:19], v[124:139]
  s_waitcnt vmcnt(12) lgkmcnt(2)
  s_barrier
  s_waitcnt lgkmcnt(1)
  v_mfma_f32_32x32x16_bf16 v[76:91], v[36:39], v[20:23], v[76:91]
  ds_read_b64_tr_b16 v[44:45], v56 offset:16384
  ds_read_b64_tr_b16 v[46:47], v56 offset:16896
  ds_read_b128 v[12:15], v54 offset:12288
  s_add_u32 s3, s68, 415744
  buffer_load_dwordx4 v[224:227], v59, s[36:39], s3 offen
  v_mfma_f32_32x32x16_bf16 v[92:107], v[40:43], v[20:23], v[92:107]
  ds_read_b64_tr_b16 v[48:49], v57 offset:16384
  ds_read_b64_tr_b16 v[50:51], v57 offset:16896
  ds_read_b128 v[16:19], v54 offset:40960
  s_waitcnt lgkmcnt(6)
  v_mfma_f32_32x32x16_bf16 v[108:123], v[36:39], v[24:27], v[108:123]
  ds_read_b64_tr_b16 v[28:29], v56 offset:20480
  ds_read_b64_tr_b16 v[30:31], v56 offset:20992
  s_add_u32 s3, s68, 422912
  buffer_load_dwordx4 v[228:231], v59, s[36:39], s3 offen
  v_mfma_f32_32x32x16_bf16 v[124:139], v[40:43], v[24:27], v[124:139]
  ds_read_b64_tr_b16 v[32:33], v57 offset:20480
  ds_read_b64_tr_b16 v[34:35], v57 offset:20992
  s_lshl_b32 s59, s49, 11
  v_add_u32 v0, s59, v2
  s_waitcnt lgkmcnt(7)
  v_mfma_f32_32x32x16_bf16 v[76:91], v[44:47], v[12:15], v[76:91]
  ds_read_b128 v[20:23], v55 offset:12288
  s_add_u32 m0, s60, 8192
  s_add_u32 s61, s61, 57344
  buffer_load_dwordx4 v58, s[28:31], s61 offen lds
  s_waitcnt lgkmcnt(6)
  v_mfma_f32_32x32x16_bf16 v[92:107], v[48:51], v[12:15], v[92:107]
  ds_read_b128 v[24:27], v55 offset:40960
  v_bfe_u32 v3, v1, 3, 1
  s_waitcnt lgkmcnt(6)
  v_mfma_f32_32x32x16_bf16 v[108:123], v[44:47], v[16:19], v[108:123]
  s_add_u32 m0, s60, 12288
  s_add_u32 s61, s61, 57344
  buffer_load_dwordx4 v58, s[28:31], s61 offen lds
  v_bfe_u32 v4, v1, 4, 1
  v_mfma_f32_32x32x16_bf16 v[124:139], v[48:51], v[16:19], v[124:139]
  s_waitcnt vmcnt(12) lgkmcnt(2)
  s_barrier
  s_waitcnt lgkmcnt(1)
  v_mfma_f32_32x32x16_bf16 v[76:91], v[28:31], v[20:23], v[76:91]
  ds_read_b64_tr_b16 v[36:37], v56 offset:24576
  ds_read_b64_tr_b16 v[38:39], v56 offset:25088
  ds_read_b128 v[12:15], v52 offset:16384
  s_add_u32 s3, s68, 530432
  buffer_load_dwordx4 v[232:235], v59, s[36:39], s3 offen
  v_mfma_f32_32x32x16_bf16 v[92:107], v[32:35], v[20:23], v[92:107]
  ds_read_b64_tr_b16 v[40:41], v57 offset:24576
  ds_read_b64_tr_b16 v[42:43], v57 offset:25088
  ds_read_b128 v[16:19], v52 offset:45056
  s_waitcnt lgkmcnt(6)
  v_mfma_f32_32x32x16_bf16 v[108:123], v[28:31], v[24:27], v[108:123]
  ds_read_b64_tr_b16 v[44:45], v56 offset:28672
  ds_read_b64_tr_b16 v[46:47], v56 offset:29184
  s_add_u32 s3, s68, 537600
  buffer_load_dwordx4 v[236:239], v59, s[36:39], s3 offen
  v_mfma_f32_32x32x16_bf16 v[124:139], v[32:35], v[24:27], v[124:139]
  ds_read_b64_tr_b16 v[48:49], v57 offset:28672
  ds_read_b64_tr_b16 v[50:51], v57 offset:29184
  v_lshl_or_b32 v3, v3, 1, v4
  v_lshlrev_b32 v3, 5, v3
  s_waitcnt lgkmcnt(7)
  v_mfma_f32_32x32x16_bf16 v[76:91], v[36:39], v[12:15], v[76:91]
  ds_read_b128 v[20:23], v53 offset:16384
  s_add_u32 m0, s60, 16384
  s_add_u32 s61, s61, 57344
  s_cmp_ge_u32 s61, s14
  s_cselect_b32 s15, 1605632, 0
  s_sub_u32 s61, s61, s15
  buffer_load_dwordx4 v58, s[28:31], s61 offen lds
  s_waitcnt lgkmcnt(6)
  v_mfma_f32_32x32x16_bf16 v[92:107], v[40:43], v[12:15], v[92:107]
  ds_read_b128 v[24:27], v53 offset:45056
  v_bfe_u32 v4, v1, 2, 2
  s_waitcnt lgkmcnt(6)
  v_mfma_f32_32x32x16_bf16 v[108:123], v[36:39], v[16:19], v[108:123]
  s_add_u32 m0, s60, 20480
  s_add_u32 s61, s61, 57344
  buffer_load_dwordx4 v58, s[28:31], s61 offen lds
  v_lshl_add_u32 v3, v4, 7, v3
  v_mfma_f32_32x32x16_bf16 v[124:139], v[40:43], v[16:19], v[124:139]
  s_waitcnt vmcnt(12) lgkmcnt(2)
  s_barrier
  s_waitcnt lgkmcnt(1)
  v_mfma_f32_32x32x16_bf16 v[76:91], v[44:47], v[20:23], v[76:91]
  ds_read_b64_tr_b16 v[28:29], v56 offset:32768
  ds_read_b64_tr_b16 v[30:31], v56 offset:33280
  ds_read_b128 v[12:15], v54 offset:16384
  s_add_u32 s3, s68, 645120
  buffer_load_dwordx4 v[240:243], v59, s[36:39], s3 offen
  v_mfma_f32_32x32x16_bf16 v[92:107], v[48:51], v[20:23], v[92:107]
  ds_read_b64_tr_b16 v[32:33], v57 offset:32768
  ds_read_b64_tr_b16 v[34:35], v57 offset:33280
  ds_read_b128 v[16:19], v54 offset:45056
  s_waitcnt lgkmcnt(6)
  v_mfma_f32_32x32x16_bf16 v[108:123], v[44:47], v[24:27], v[108:123]
  ds_read_b64_tr_b16 v[36:37], v56 offset:36864
  ds_read_b64_tr_b16 v[38:39], v56 offset:37376
  s_add_u32 s3, s68, 652288
  buffer_load_dwordx4 v[244:247], v59, s[36:39], s3 offen
  v_mfma_f32_32x32x16_bf16 v[124:139], v[48:51], v[24:27], v[124:139]
  ds_read_b64_tr_b16 v[40:41], v57 offset:36864
  ds_read_b64_tr_b16 v[42:43], v57 offset:37376
  v_lshl_add_u32 v3, v9, 9, v3
  v_and_b32 v4, 3, v1
  s_waitcnt lgkmcnt(7)
  v_mfma_f32_32x32x16_bf16 v[76:91], v[28:31], v[12:15], v[76:91]
  ds_read_b128 v[20:23], v55 offset:16384
  s_add_u32 m0, s60, 24576
  s_add_u32 s61, s61, 57344
  buffer_load_dwordx4 v58, s[28:31], s61 offen lds
  s_waitcnt lgkmcnt(6)
  v_mfma_f32_32x32x16_bf16 v[92:107], v[32:35], v[12:15], v[92:107]
  ds_read_b128 v[24:27], v55 offset:45056
  v_lshl_add_u32 v3, v4, 3, v3
  s_waitcnt lgkmcnt(6)
  v_mfma_f32_32x32x16_bf16 v[108:123], v[28:31], v[16:19], v[108:123]
  s_add_u32 m0, s60, 28672
  s_add_u32 s61, s61, 57344
  buffer_load_dwordx4 v58, s[28:31], s61 offen lds
  v_add_u32 v7, s59, v3
  v_mfma_f32_32x32x16_bf16 v[124:139], v[32:35], v[16:19], v[124:139]
  s_waitcnt vmcnt(12) lgkmcnt(2)
  s_barrier
  s_waitcnt lgkmcnt(1)
  v_mfma_f32_32x32x16_bf16 v[76:91], v[36:39], v[20:23], v[76:91]
  ds_read_b64_tr_b16 v[44:45], v56 offset:0
  ds_read_b64_tr_b16 v[46:47], v56 offset:512
  ds_read_b128 v[12:15], v52 offset:20480
  s_add_u32 s3, s68, 759808
  buffer_load_dwordx4 v[248:251], v59, s[36:39], s3 offen
  v_mfma_f32_32x32x16_bf16 v[92:107], v[40:43], v[20:23], v[92:107]
  ds_read_b64_tr_b16 v[48:49], v57 offset:0
  ds_read_b64_tr_b16 v[50:51], v57 offset:512
  ds_read_b128 v[16:19], v52 offset:49152
  s_waitcnt lgkmcnt(6)
  v_mfma_f32_32x32x16_bf16 v[108:123], v[36:39], v[24:27], v[108:123]
  ds_read_b64_tr_b16 v[28:29], v56 offset:4096
  ds_read_b64_tr_b16 v[30:31], v56 offset:4608
  s_add_u32 s3, s68, 766976
  buffer_load_dwordx4 v[252:255], v59, s[36:39], s3 offen
  v_mfma_f32_32x32x16_bf16 v[124:139], v[40:43], v[24:27], v[124:139]
  ds_read_b64_tr_b16 v[32:33], v57 offset:4096
  ds_read_b64_tr_b16 v[34:35], v57 offset:4608
  v_xor_b32 v8, 64, v7
  s_waitcnt lgkmcnt(7)
  v_mfma_f32_32x32x16_bf16 v[76:91], v[44:47], v[12:15], v[76:91]
  ds_read_b128 v[20:23], v53 offset:20480
  s_waitcnt lgkmcnt(6)
  v_mfma_f32_32x32x16_bf16 v[92:107], v[48:51], v[12:15], v[92:107]
  ds_read_b128 v[24:27], v53 offset:49152
  s_waitcnt lgkmcnt(6)
  v_mfma_f32_32x32x16_bf16 v[108:123], v[44:47], v[16:19], v[108:123]
  v_mfma_f32_32x32x16_bf16 v[124:139], v[48:51], v[16:19], v[124:139]
  s_waitcnt vmcnt(10) lgkmcnt(2)
  s_barrier
  s_waitcnt lgkmcnt(1)
  v_mfma_f32_32x32x16_bf16 v[76:91], v[28:31], v[20:23], v[76:91]
  ds_read_b64_tr_b16 v[36:37], v56 offset:8192
  ds_read_b64_tr_b16 v[38:39], v56 offset:8704
  ds_read_b128 v[12:15], v54 offset:20480
  s_add_u32 m0, s63, 0
  s_add_u32 s3, s68, 0
  buffer_load_dwordx4 v59, s[36:39], s3 offen lds
  v_mfma_f32_32x32x16_bf16 v[92:107], v[32:35], v[20:23], v[92:107]
  ds_read_b64_tr_b16 v[40:41], v57 offset:8192
  ds_read_b64_tr_b16 v[42:43], v57 offset:8704
  ds_read_b128 v[16:19], v54 offset:49152
  s_waitcnt lgkmcnt(6)
  v_mfma_f32_32x32x16_bf16 v[108:123], v[28:31], v[24:27], v[108:123]
  ds_read_b64_tr_b16 v[44:45], v56 offset:12288
  ds_read_b64_tr_b16 v[46:47], v56 offset:12800
  s_add_u32 m0, s63, 1024
  s_add_u32 s3, s68, 7168
  buffer_load_dwordx4 v59, s[36:39], s3 offen lds
  v_mfma_f32_32x32x16_bf16 v[124:139], v[32:35], v[24:27], v[124:139]
  ds_read_b64_tr_b16 v[48:49], v57 offset:12288
  ds_read_b64_tr_b16 v[50:51], v57 offset:12800
  s_waitcnt lgkmcnt(7)
  v_mfma_f32_32x32x16_bf16 v[76:91], v[36:39], v[12:15], v[76:91]
  ds_read_b128 v[20:23], v55 offset:20480
  s_waitcnt lgkmcnt(6)
  v_mfma_f32_32x32x16_bf16 v[92:107], v[40:43], v[12:15], v[92:107]
  ds_read_b128 v[24:27], v55 offset:49152
  ds_read_b128 v[64:67], v61
  ds_read_b128 v[68:71], v61 offset:2048
  s_waitcnt lgkmcnt(8)
  v_mfma_f32_32x32x16_bf16 v[108:123], v[36:39], v[16:19], v[108:123]
  v_mfma_f32_32x32x16_bf16 v[124:139], v[40:43], v[16:19], v[124:139]
  s_waitcnt vmcnt(8) lgkmcnt(4)
  s_barrier
  s_waitcnt lgkmcnt(3)
  v_mfma_f32_32x32x16_bf16 v[76:91], v[44:47], v[20:23], v[76:91]
  ds_read_b64_tr_b16 v[28:29], v56 offset:16384
  ds_read_b64_tr_b16 v[30:31], v56 offset:16896
  ds_read_b128 v[12:15], v52 offset:24576
  s_add_u32 m0, s63, 2048
  s_add_u32 s3, s68, 114688
  buffer_load_dwordx4 v59, s[36:39], s3 offen lds
  v_mfma_f32_32x32x16_bf16 v[92:107], v[48:51], v[20:23], v[92:107]
  ds_read_b64_tr_b16 v[32:33], v57 offset:16384
  ds_read_b64_tr_b16 v[34:35], v57 offset:16896
  ds_read_b128 v[16:19], v52 offset:53248
  s_waitcnt lgkmcnt(8)
  v_mfma_f32_32x32x16_bf16 v[108:123], v[44:47], v[24:27], v[108:123]
  ds_read_b64_tr_b16 v[36:37], v56 offset:20480
  ds_read_b64_tr_b16 v[38:39], v56 offset:20992
  s_add_u32 m0, s63, 3072
  s_add_u32 s3, s68, 121856
  buffer_load_dwordx4 v59, s[36:39], s3 offen lds
  v_mfma_f32_32x32x16_bf16 v[124:139], v[48:51], v[24:27], v[124:139]
  ds_read_b64_tr_b16 v[40:41], v57 offset:20480
  ds_read_b64_tr_b16 v[42:43], v57 offset:20992
  s_waitcnt lgkmcnt(7)
  v_mfma_f32_32x32x16_bf16 v[76:91], v[28:31], v[12:15], v[76:91]
  ds_read_b128 v[20:23], v53 offset:24576
  s_waitcnt lgkmcnt(6)
  v_mfma_f32_32x32x16_bf16 v[92:107], v[32:35], v[12:15], v[92:107]
  ds_read_b128 v[24:27], v53 offset:53248
  s_waitcnt lgkmcnt(6)
  v_mfma_f32_32x32x16_bf16 v[108:123], v[28:31], v[16:19], v[108:123]
  v_mfma_f32_32x32x16_bf16 v[124:139], v[32:35], v[16:19], v[124:139]
  s_waitcnt vmcnt(6) lgkmcnt(2)
  s_barrier
  s_waitcnt lgkmcnt(1)
  v_mfma_f32_32x32x16_bf16 v[76:91], v[36:39], v[20:23], v[76:91]
  ds_read_b64_tr_b16 v[44:45], v56 offset:24576
  ds_read_b64_tr_b16 v[46:47], v56 offset:25088
  ds_read_b128 v[12:15], v54 offset:24576
  s_add_u32 m0, s63, 4096
  s_add_u32 s3, s68, 229376
  buffer_load_dwordx4 v59, s[36:39], s3 offen lds
  ds_read_b32 v72, v60 offset:1536
  ds_read_b32 v74, v60 offset:3584
  v_mfma_f32_32x32x16_bf16 v[92:107], v[40:43], v[20:23], v[92:107]
  ds_read_b64_tr_b16 v[48:49], v57 offset:24576
  ds_read_b64_tr_b16 v[50:51], v57 offset:25088
  ds_read_b128 v[16:19], v54 offset:53248
  s_waitcnt lgkmcnt(8)
  v_mfma_f32_32x32x16_bf16 v[108:123], v[36:39], v[24:27], v[108:123]
  ds_read_b64_tr_b16 v[28:29], v56 offset:28672
  ds_read_b64_tr_b16 v[30:31], v56 offset:29184
  s_add_u32 m0, s63, 5120
  s_add_u32 s3, s68, 236544
  buffer_load_dwordx4 v59, s[36:39], s3 offen lds
  v_mfma_f32_32x32x16_bf16 v[124:139], v[40:43], v[24:27], v[124:139]
  ds_read_b64_tr_b16 v[32:33], v57 offset:28672
  ds_read_b64_tr_b16 v[34:35], v57 offset:29184
  s_waitcnt lgkmcnt(8)
  v_and_b32 v73, 0xffff, v72
  s_waitcnt lgkmcnt(7)
  v_and_b32 v75, 0xffff, v74
  v_mfma_f32_32x32x8_bf16 v[76:91], v[72:73], v[66:67], v[76:91]
  s_nop 0
  v_mfma_f32_32x32x8_bf16 v[92:107], v[74:75], v[66:67], v[92:107]
  v_mfma_f32_32x32x8_bf16 v[108:123], v[72:73], v[70:71], v[108:123]
  v_mfma_f32_32x32x8_bf16 v[124:139], v[74:75], v[70:71], v[124:139]
  s_nop 5
  v_mfma_f32_32x32x16_bf16 v[76:91], v[44:47], v[12:15], v[76:91]
  ds_read_b128 v[20:23], v55 offset:24576
  s_waitcnt lgkmcnt(6)
  v_mfma_f32_32x32x16_bf16 v[92:107], v[48:51], v[12:15], v[92:107]
  ds_read_b128 v[24:27], v55 offset:53248
  s_waitcnt lgkmcnt(6)
  v_mfma_f32_32x32x16_bf16 v[108:123], v[44:47], v[16:19], v[108:123]
  v_mfma_f32_32x32x16_bf16 v[124:139], v[48:51], v[16:19], v[124:139]
  s_waitcnt lgkmcnt(2)
  s_barrier
  s_waitcnt lgkmcnt(1)
  v_mfma_f32_32x32x16_bf16 v[76:91], v[28:31], v[20:23], v[76:91]
  v_mfma_f32_32x32x16_bf16 v[92:107], v[32:35], v[20:23], v[92:107]
  s_waitcnt lgkmcnt(0)
  v_mfma_f32_32x32x16_bf16 v[108:123], v[28:31], v[24:27], v[108:123]
  v_mfma_f32_32x32x16_bf16 v[124:139], v[32:35], v[24:27], v[124:139]
  s_lshl_b32 s56, s55, 1
  s_xor_b32 s56, s56, s49
  s_lshl_b32 s56, s56, 5
  v_xor_b32 v57, s56, v56
  s_cmp_lt_u32 s50, 14
  s_cselect_b32 s56, 0x100001, 0
  v_lshrrev_b32 v52, v10, s56
  v_and_b32 v52, 1, v52
  v_mul_u32_u24 v52, 0x3f80, v52
  v_lshl_or_b32 v52, v52, 16, v52
  v_mov_b32 v53, v52
  v_mov_b64 v[54:55], v[52:53]
  ds_read_b64_tr_b16 v[44:45], v57 offset:32768
  ds_read_b64_tr_b16 v[46:47], v57 offset:33280
  ds_read_b64_tr_b16 v[48:49], v57 offset:36864
  ds_read_b64_tr_b16 v[50:51], v57 offset:37376
  s_add_u32 m0, s63, 6144
  s_add_u32 s3, s68, 344064
  buffer_load_dwordx4 v59, s[36:39], s3 offen lds
  s_add_u32 m0, s63, 7168
  s_add_u32 s3, s68, 351232
  buffer_load_dwordx4 v59, s[36:39], s3 offen lds
  v_mul_f32 v76, v76, v64
  v_mul_f32 v77, v77, v64
  v_mul_f32 v78, v78, v64
  v_mul_f32 v79, v79, v64
  v_mul_f32 v80, v80, v64
  v_mul_f32 v81, v81, v64
  v_mul_f32 v82, v82, v64
  v_mul_f32 v83, v83, v64
  s_waitcnt lgkmcnt(2)
  v_mfma_f32_16x16x32_bf16 v[12:15], v[52:55], v[44:47], 0
  s_waitcnt lgkmcnt(0)
  v_mfma_f32_16x16x32_bf16 v[12:15], v[52:55], v[48:51], v[12:15]
  s_barrier
  ds_read_b64_tr_b16 v[44:45], v57 offset:0
  ds_read_b64_tr_b16 v[46:47], v57 offset:512
  ds_read_b64_tr_b16 v[48:49], v57 offset:4096
  ds_read_b64_tr_b16 v[50:51], v57 offset:4608
  s_add_u32 m0, s63, 8192
  s_add_u32 s3, s68, 458752
  buffer_load_dwordx4 v59, s[36:39], s3 offen lds
  s_add_u32 m0, s63, 9216
  s_add_u32 s3, s68, 465920
  buffer_load_dwordx4 v59, s[36:39], s3 offen lds
  v_exp_f32 v76, v76
  v_exp_f32 v77, v77
  v_exp_f32 v78, v78
  v_exp_f32 v79, v79
  v_exp_f32 v80, v80
  v_exp_f32 v81, v81
  v_exp_f32 v82, v82
  v_exp_f32 v83, v83
  v_fma_f32 v76, v76, v65, v65
  v_fma_f32 v77, v77, v65, v65
  v_fma_f32 v78, v78, v65, v65
  v_fma_f32 v79, v79, v65, v65
  v_fma_f32 v80, v80, v65, v65
  v_fma_f32 v81, v81, v65, v65
  v_fma_f32 v82, v82, v65, v65
  v_fma_f32 v83, v83, v65, v65
  v_rcp_f32 v76, v76
  v_rcp_f32 v77, v77
  v_rcp_f32 v78, v78
  s_waitcnt lgkmcnt(2)
  v_mfma_f32_16x16x32_bf16 v[16:19], v[52:55], v[44:47], 0
  s_waitcnt lgkmcnt(0)
  v_mfma_f32_16x16x32_bf16 v[16:19], v[52:55], v[48:51], v[16:19]
  s_barrier
  s_bitcmp1_b32 s50, 0
  s_cselect_b64 vcc, -1, 0
  s_nop 4
  v_cndmask_b32 v12, v12, v16, vcc
  s_lshl_b32 s62, s50, 7
  v_lshl_add_u32 v13, v10, 2, s62
  v_or_b32 v12, 1, v12
  s_mov_b32 exec_hi, 0
  buffer_store_dword v12, v13, s[32:35], s40 offen sc1
  s_mov_b64 exec, -1
  s_add_u32 m0, s63, 10240
  s_add_u32 s3, s68, 573440
  buffer_load_dwordx4 v59, s[36:39], s3 offen lds
  v_rcp_f32 v79, v79
  v_rcp_f32 v80, v80
  v_rcp_f32 v81, v81
  v_rcp_f32 v82, v82
  v_rcp_f32 v83, v83
  v_mul_f32 v84, v84, v76
  v_mul_f32 v85, v85, v77
  v_mul_f32 v86, v86, v78
  v_mul_f32 v87, v87, v79
  v_mul_f32 v88, v88, v80
  v_mul_f32 v89, v89, v81
  v_mul_f32 v90, v90, v82
  v_mul_f32 v91, v91, v83
  v_cvt_pk_bf16_f32 v76, v84, v85
  v_cvt_pk_bf16_f32 v77, v86, v87
  v_cvt_pk_bf16_f32 v78, v88, v89
  v_cvt_pk_bf16_f32 v79, v90, v91
  v_mul_f32 v108, v108, v68
  v_mul_f32 v109, v109, v68
  v_mul_f32 v110, v110, v68
  v_mul_f32 v111, v111, v68
  v_mul_f32 v112, v112, v68
  v_mul_f32 v113, v113, v68
  v_mul_f32 v114, v114, v68
  v_mul_f32 v115, v115, v68
  s_barrier
  s_add_u32 s3, s69, 0
  buffer_store_dwordx4 v[76:79], v2, s[32:35], s3 offen sc1
  v_exp_f32 v108, v108
  v_exp_f32 v109, v109
  v_exp_f32 v110, v110
  v_exp_f32 v111, v111
  v_exp_f32 v112, v112
  v_exp_f32 v113, v113
  v_exp_f32 v114, v114
  v_exp_f32 v115, v115
  v_fma_f32 v108, v108, v69, v69
  v_fma_f32 v109, v109, v69, v69
  v_fma_f32 v110, v110, v69, v69
  v_fma_f32 v111, v111, v69, v69
  v_fma_f32 v112, v112, v69, v69
  v_fma_f32 v113, v113, v69, v69
  v_fma_f32 v114, v114, v69, v69
  v_fma_f32 v115, v115, v69, v69
  v_rcp_f32 v108, v108
  v_rcp_f32 v109, v109
  v_rcp_f32 v110, v110
  v_rcp_f32 v111, v111
  v_rcp_f32 v112, v112
  v_rcp_f32 v113, v113
  v_rcp_f32 v114, v114
  s_barrier
  s_add_u32 m0, s63, 11264
  s_add_u32 s3, s68, 580608
  buffer_load_dwordx4 v59, s[36:39], s3 offen lds
  s_add_u32 m0, s63, 12288
  s_add_u32 s3, s68, 688128
  buffer_load_dwordx4 v59, s[36:39], s3 offen lds
  v_rcp_f32 v115, v115
  v_mul_f32 v116, v116, v108
  v_mul_f32 v117, v117, v109
  v_mul_f32 v118, v118, v110
  v_mul_f32 v119, v119, v111
  v_mul_f32 v120, v120, v112
  v_mul_f32 v121, v121, v113
  v_mul_f32 v122, v122, v114
  v_mul_f32 v123, v123, v115
  v_cvt_pk_bf16_f32 v108, v116, v117
  v_cvt_pk_bf16_f32 v109, v118, v119
  v_cvt_pk_bf16_f32 v110, v120, v121
  v_cvt_pk_bf16_f32 v111, v122, v123
  v_mul_f32 v92, v92, v64
  v_mul_f32 v93, v93, v64
  v_mul_f32 v94, v94, v64
  v_mul_f32 v95, v95, v64
  v_mul_f32 v96, v96, v64
  v_mul_f32 v97, v97, v64
  v_mul_f32 v98, v98, v64
  v_mul_f32 v99, v99, v64
  v_exp_f32 v92, v92
  v_exp_f32 v93, v93
  v_exp_f32 v94, v94
  v_exp_f32 v95, v95
  v_exp_f32 v96, v96
  v_exp_f32 v97, v97
  v_exp_f32 v98, v98
  s_barrier
  s_add_u32 s3, s69, 115712
  buffer_store_dwordx4 v[108:111], v2, s[32:35], s3 offen sc1
  v_exp_f32 v99, v99
  v_fma_f32 v92, v92, v65, v65
  v_fma_f32 v93, v93, v65, v65
  v_fma_f32 v94, v94, v65, v65
  v_fma_f32 v95, v95, v65, v65
  v_fma_f32 v96, v96, v65, v65
  v_fma_f32 v97, v97, v65, v65
  v_fma_f32 v98, v98, v65, v65
  v_fma_f32 v99, v99, v65, v65
  v_rcp_f32 v92, v92
  v_rcp_f32 v93, v93
  v_rcp_f32 v94, v94
  v_rcp_f32 v95, v95
  v_rcp_f32 v96, v96
  v_rcp_f32 v97, v97
  v_rcp_f32 v98, v98
  v_rcp_f32 v99, v99
  v_mul_f32 v100, v100, v92
  v_mul_f32 v101, v101, v93
  v_mul_f32 v102, v102, v94
  v_mul_f32 v103, v103, v95
  v_mul_f32 v104, v104, v96
  v_mul_f32 v105, v105, v97
  v_mul_f32 v106, v106, v98
  v_mul_f32 v107, v107, v99
  v_cvt_pk_bf16_f32 v92, v100, v101
  v_cvt_pk_bf16_f32 v93, v102, v103
  v_cvt_pk_bf16_f32 v94, v104, v105
  v_cvt_pk_bf16_f32 v95, v106, v107
  v_mul_f32 v124, v124, v68
  s_barrier
  s_add_u32 s3, s69, 14336
  buffer_store_dwordx4 v[92:95], v2, s[32:35], s3 offen sc1
  v_mul_f32 v125, v125, v68
  v_mul_f32 v126, v126, v68
  v_mul_f32 v127, v127, v68
  v_mul_f32 v128, v128, v68
  v_mul_f32 v129, v129, v68
  v_mul_f32 v130, v130, v68
  v_mul_f32 v131, v131, v68
  v_exp_f32 v124, v124
  v_exp_f32 v125, v125
  v_exp_f32 v126, v126
  v_exp_f32 v127, v127
  v_exp_f32 v128, v128
  v_exp_f32 v129, v129
  v_exp_f32 v130, v130
  v_exp_f32 v131, v131
  v_fma_f32 v124, v124, v69, v69
  v_fma_f32 v125, v125, v69, v69
  v_fma_f32 v126, v126, v69, v69
  v_fma_f32 v127, v127, v69, v69
  v_fma_f32 v128, v128, v69, v69
  v_fma_f32 v129, v129, v69, v69
  v_fma_f32 v130, v130, v69, v69
  v_fma_f32 v131, v131, v69, v69
  v_rcp_f32 v124, v124
  v_rcp_f32 v125, v125
  v_rcp_f32 v126, v126
  v_rcp_f32 v127, v127
  s_barrier
  s_add_u32 m0, s63, 13312
  s_add_u32 s3, s68, 695296
  buffer_load_dwordx4 v59, s[36:39], s3 offen lds
  s_add_u32 m0, s63, 14336
  s_add_u32 s3, s68, 14336
  buffer_load_dwordx4 v59, s[36:39], s3 offen lds
  v_rcp_f32 v128, v128
  v_rcp_f32 v129, v129
  v_rcp_f32 v130, v130
  v_rcp_f32 v131, v131
  v_mul_f32 v132, v132, v124
  v_mul_f32 v133, v133, v125
  v_mul_f32 v134, v134, v126
  v_mul_f32 v135, v135, v127
  v_mul_f32 v136, v136, v128
  v_mul_f32 v137, v137, v129
  v_mul_f32 v138, v138, v130
  v_mul_f32 v139, v139, v131
  v_cvt_pk_bf16_f32 v124, v132, v133
  v_cvt_pk_bf16_f32 v125, v134, v135
  v_cvt_pk_bf16_f32 v126, v136, v137
  v_cvt_pk_bf16_f32 v127, v138, v139
  v_and_b32 v3, 7, v10
  v_xor_b32 v3, v3, v9
  v_lshlrev_b32 v3, 4, v3
  v_lshl_add_u32 v3, v10, 8, v3
  v_add_u32 v3, s10, v3
  v_xor_b32 v4, 32, v3
  v_xor_b32 v5, 64, v3
  v_xor_b32 v6, 96, v3
  s_lshl_b32 s56, s49, 11
  s_sub_u32 s56, s10, s56
  v_add_u32 v10, s56, v7
  v_add_u32 v11, s56, v8
  v_mov_b32 v9, v59
  s_barrier
  buffer_load_dwordx4 v[44:47], v2, s[32:35], s40 offen offset:0 sc1
  buffer_load_dwordx4 v[48:51], v2, s[32:35], s40 offen offset:1024 sc1
  s_waitcnt vmcnt(5)
  s_mov_b64 exec, 0x7f
  buffer_atomic_add v63, v62, s[32:35], 0 offen offset:0 sc1
  s_mov_b64 exec, -1
  s_add_u32 s3, s69, 130048
  buffer_store_dwordx4 v[124:127], v2, s[32:35], s3 offen sc1
  s_barrier
  v_and_b32 v53, 7, v1
  v_lshrrev_b32 v52, 4, v1
  v_lshl_add_u32 v53, v53, 2, v52
  v_and_b32 v52, 8, v1
  v_lshl_add_u32 v53, v52, 2, v53
  s_lshl_b32 s62, s49, 11
  v_lshl_add_u32 v53, v53, 2, s62
  s_add_u32 m0, s63, 15360
  s_add_u32 s3, s68, 21504
  buffer_load_dwordx4 v59, s[36:39], s3 offen lds
  s_add_u32 m0, s63, 16384
  s_add_u32 s3, s68, 129024
  buffer_load_dwordx4 v59, s[36:39], s3 offen lds
  ds_write_b128 v0, v[144:147] offset:0
  ds_read_b64_tr_b16 v[140:141], v7 offset:0
  ds_read_b64_tr_b16 v[144:145], v8 offset:0
  s_barrier
  s_add_u32 m0, s63, 17408
  s_add_u32 s3, s68, 136192
  buffer_load_dwordx4 v59, s[36:39], s3 offen lds
  s_add_u32 m0, s63, 18432
  s_add_u32 s3, s68, 243712
  buffer_load_dwordx4 v59, s[36:39], s3 offen lds
  s_add_u32 m0, s63, 19456
  s_add_u32 s3, s68, 250880
  buffer_load_dwordx4 v59, s[36:39], s3 offen lds
  s_add_u32 m0, s63, 20480
  s_add_u32 s3, s68, 358400
  buffer_load_dwordx4 v59, s[36:39], s3 offen lds
  s_mov_b32 s62, 0
  s_waitcnt vmcnt(8)
L_chk18:
  v_min3_u32 v52, v44, v45, v46
  v_min3_u32 v52, v52, v47, v48
  v_min3_u32 v52, v52, v49, v50
  v_min_u32 v52, v52, v51
  v_cmp_eq_u32 vcc, 0, v52
  s_cbranch_vccz L_cend19
  s_add_u32 s62, s62, 1
  s_cmp_gt_u32 s62, 0x8000
  s_cbranch_scc1 L_cend19
  buffer_load_dwordx4 v[44:47], v2, s[32:35], s40 offen offset:0 sc1
  buffer_load_dwordx4 v[48:51], v2, s[32:35], s40 offen offset:1024 sc1
  s_waitcnt vmcnt(0)
  s_branch L_chk18
L_cend19:
  v_add_f32 v44, v44, v48
  v_add_f32 v45, v45, v49
  v_add_f32 v46, v46, v50
  v_add_f32 v47, v47, v51
  ds_write_b128 v0, v[148:151] offset:0
  ds_read_b64_tr_b16 v[142:143], v7 offset:0
  ds_read_b64_tr_b16 v[146:147], v8 offset:0
  s_barrier
  s_waitcnt vmcnt(6)
  s_mov_b64 exec, 0x7f
  buffer_atomic_add v63, v62, s[32:35], 0 offen offset:8 sc1
  s_mov_b64 exec, -1
  s_add_u32 m0, s63, 21504
  s_add_u32 s3, s68, 365568
  buffer_load_dwordx4 v59, s[36:39], s3 offen lds
  v_permlane16_swap_b32 v44, v45
  v_permlane16_swap_b32 v46, v47
  v_add_f32 v44, v44, v45
  v_add_f32 v46, v46, v47
  s_nop 1
  v_permlane32_swap_b32 v44, v46
  v_add_f32 v44, v44, v46
  v_cvt_pk_bf16_f32 v45, v44, v44
  v_and_b32 v45, 0xffff0000, v45
  v_sub_f32 v45, v44, v45
  v_cvt_pk_bf16_f32 v44, v44, v45
  ds_write_b32 v53, v44 offset:1536
  ds_read_b32 v52, v53
  s_waitcnt lgkmcnt(1)
  s_mov_b32 s13, 0
  s_atomic_add s13, s[22:23], s6 glc
  s_barrier
  s_setprio 1
  s_add_u32 m0, s63, 22528
  s_add_u32 s3, s68, 473088
  buffer_load_dwordx4 v9, s[36:39], s3 offen lds
  s_add_u32 m0, s63, 23552
  s_add_u32 s3, s68, 480256
  buffer_load_dwordx4 v9, s[36:39], s3 offen lds
  s_add_u32 m0, s63, 24576
  s_add_u32 s3, s68, 587776
  buffer_load_dwordx4 v9, s[36:39], s3 offen lds
  s_add_u32 m0, s63, 25600
  s_add_u32 s3, s68, 594944
  buffer_load_dwordx4 v9, s[36:39], s3 offen lds
  ds_write_b128 v0, v[152:155] offset:0
  ds_read_b64_tr_b16 v[148:149], v7 offset:0
  ds_read_b64_tr_b16 v[152:153], v8 offset:0
  ds_write_b128 v0, v[156:159] offset:0
  ds_read_b64_tr_b16 v[150:151], v7 offset:0
  ds_read_b64_tr_b16 v[154:155], v8 offset:0
  s_waitcnt lgkmcnt(0)
  s_cmp_ge_u32 s13, 14
  s_cbranch_scc1 L_pf20
  s_mov_b32 s62, 0
L_poll21:
  s_mov_b32 s13, 0
  s_atomic_add s13, s[22:23], s6 glc
  s_add_u32 s62, s62, 1
  s_waitcnt lgkmcnt(0)
  s_cmp_gt_u32 s62, 0x8000
  s_cbranch_scc1 L_pend22
  s_cmp_lt_u32 s13, 14
  s_cbranch_scc1 L_poll21
L_pend22:
L_pf20:
  s_add_u32 s6, s6, 8
  s_add_u32 s64, s66, 0
  buffer_load_dwordx4 v[12:15], v2, s[32:35], s64 offen offset:0 sc1
  s_add_u32 s65, s66, 115712
  buffer_load_dwordx4 v[16:19], v2, s[32:35], s65 offen offset:0 sc1
  buffer_load_dwordx4 v[20:23], v2, s[32:35], s64 offen offset:1024 sc1
  buffer_load_dwordx4 v[24:27], v2, s[32:35], s65 offen offset:1024 sc1
  buffer_load_dwordx4 v[28:31], v2, s[32:35], s64 offen offset:2048 sc1
  buffer_load_dwordx4 v[32:35], v2, s[32:35], s65 offen offset:2048 sc1
  buffer_load_dwordx4 v[36:39], v2, s[32:35], s64 offen offset:3072 sc1
  buffer_load_dwordx4 v[40:43], v2, s[32:35], s65 offen offset:3072 sc1
  ds_read_b64_tr_b16 v[60:61], v10 offset:0
  ds_read_b64_tr_b16 v[62:63], v10 offset:1024
  ds_read_b64_tr_b16 v[64:65], v11 offset:0
  ds_read_b64_tr_b16 v[66:67], v11 offset:1024
  ds_write_b128 v0, v[160:163] offset:0
  ds_read_b64_tr_b16 v[156:157], v7 offset:0
  ds_read_b64_tr_b16 v[160:161], v8 offset:0
  ds_write_b128 v0, v[164:167] offset:0
  ds_read_b64_tr_b16 v[158:159], v7 offset:0
  ds_read_b64_tr_b16 v[162:163], v8 offset:0
  ds_write_b128 v0, v[168:171] offset:0
  ds_read_b64_tr_b16 v[164:165], v7 offset:0
  ds_read_b64_tr_b16 v[168:169], v8 offset:0
  ds_write_b128 v0, v[172:175] offset:0
  ds_read_b64_tr_b16 v[166:167], v7 offset:0
  ds_read_b64_tr_b16 v[170:171], v8 offset:0
  ds_write_b128 v0, v[176:179] offset:0
  ds_read_b64_tr_b16 v[172:173], v7 offset:0
  ds_read_b64_tr_b16 v[176:177], v8 offset:0
  ds_write_b128 v0, v[180:183] offset:0
  ds_read_b64_tr_b16 v[174:175], v7 offset:0
  ds_read_b64_tr_b16 v[178:179], v8 offset:0
  ds_write_b128 v0, v[184:187] offset:0
  ds_read_b64_tr_b16 v[180:181], v7 offset:0
  ds_read_b64_tr_b16 v[184:185], v8 offset:0
  ds_write_b128 v0, v[188:191] offset:0
  ds_read_b64_tr_b16 v[182:183], v7 offset:0
  ds_read_b64_tr_b16 v[186:187], v8 offset:0
  s_waitcnt vmcnt(7) lgkmcnt(15)
  v_mfma_f32_32x32x16_bf16 v[76:91], v[60:63], v[12:15], 0
  ds_read_b64_tr_b16 v[68:69], v10 offset:2048
  ds_read_b64_tr_b16 v[70:71], v10 offset:3072
  ds_read_b64_tr_b16 v[72:73], v11 offset:2048
  ds_read_b64_tr_b16 v[74:75], v11 offset:3072
  v_mfma_f32_32x32x16_bf16 v[92:107], v[64:67], v[12:15], 0
  s_add_u32 s64, s66, 4096
  buffer_load_dwordx4 v[44:47], v2, s[32:35], s64 offen offset:0 sc1
  s_add_u32 s65, s66, 119808
  buffer_load_dwordx4 v[48:51], v2, s[32:35], s65 offen offset:0 sc1
  s_mov_b32 s13, 0
  s_atomic_add s13, s[22:23], s6 glc
  s_waitcnt vmcnt(8)
  v_mfma_f32_32x32x16_bf16 v[108:123], v[60:63], v[16:19], 0
  v_mfma_f32_32x32x16_bf16 v[124:139], v[64:67], v[16:19], 0
  buffer_load_dwordx4 v[52:55], v2, s[32:35], s64 offen offset:1024 sc1
  buffer_load_dwordx4 v[56:59], v2, s[32:35], s65 offen offset:1024 sc1
  s_waitcnt vmcnt(9) lgkmcnt(2)
  v_mfma_f32_32x32x16_bf16 v[76:91], v[68:71], v[20:23], v[76:91]
  ds_read_b64_tr_b16 v[60:61], v10 offset:4096
  ds_read_b64_tr_b16 v[62:63], v10 offset:5120
  ds_read_b64_tr_b16 v[64:65], v11 offset:4096
  ds_read_b64_tr_b16 v[66:67], v11 offset:5120
  s_waitcnt lgkmcnt(4)
  v_mfma_f32_32x32x16_bf16 v[92:107], v[72:75], v[20:23], v[92:107]
  s_add_u32 m0, s63, 26624
  s_add_u32 s3, s68, 702464
  buffer_load_dwordx4 v9, s[36:39], s3 offen lds
  buffer_load_dwordx4 v[12:15], v2, s[32:35], s64 offen offset:2048 sc1
  buffer_load_dwordx4 v[16:19], v2, s[32:35], s65 offen offset:2048 sc1
  ds_write_b128 v0, v[192:195] offset:0
  ds_read_b64_tr_b16 v[188:189], v7 offset:0
  ds_read_b64_tr_b16 v[192:193], v8 offset:0
  s_waitcnt vmcnt(11)
  v_mfma_f32_32x32x16_bf16 v[108:123], v[68:71], v[24:27], v[108:123]
  v_mfma_f32_32x32x16_bf16 v[124:139], v[72:75], v[24:27], v[124:139]
  s_add_u32 m0, s63, 27648
  s_add_u32 s3, s68, 709632
  buffer_load_dwordx4 v9, s[36:39], s3 offen lds
  ds_write_b128 v0, v[196:199] offset:0
  ds_read_b64_tr_b16 v[190:191], v7 offset:0
  ds_read_b64_tr_b16 v[194:195], v8 offset:0
  s_waitcnt vmcnt(11) lgkmcnt(8)
  v_mfma_f32_32x32x16_bf16 v[76:91], v[60:63], v[28:31], v[76:91]
  ds_read_b64_tr_b16 v[68:69], v10 offset:6144
  ds_read_b64_tr_b16 v[70:71], v10 offset:7168
  ds_read_b64_tr_b16 v[72:73], v11 offset:6144
  ds_read_b64_tr_b16 v[74:75], v11 offset:7168
  s_waitcnt lgkmcnt(10)
  v_mfma_f32_32x32x16_bf16 v[92:107], v[64:67], v[28:31], v[92:107]
  s_waitcnt vmcnt(10)
  v_mfma_f32_32x32x16_bf16 v[108:123], v[60:63], v[32:35], v[108:123]
  v_mfma_f32_32x32x16_bf16 v[124:139], v[64:67], v[32:35], v[124:139]
  s_waitcnt lgkmcnt(0)
  s_cmp_ge_u32 s13, 14
  s_cbranch_scc1 L_pf23
  s_mov_b32 s62, 0
L_poll24:
  s_mov_b32 s13, 0
  s_atomic_add s13, s[22:23], s6 glc
  s_add_u32 s62, s62, 1
  s_waitcnt lgkmcnt(0)
  s_cmp_gt_u32 s62, 0x8000
  s_cbranch_scc1 L_pend25
  s_cmp_lt_u32 s13, 14
  s_cbranch_scc1 L_poll24
L_pend25:
L_pf23:
  s_add_u32 s6, s6, 8
  s_add_u32 s64, s66, 14336
  buffer_load_dwordx4 v[20:23], v2, s[32:35], s64 offen offset:0 sc1
  s_add_u32 s65, s66, 130048
  buffer_load_dwordx4 v[24:27], v2, s[32:35], s65 offen offset:0 sc1
  ds_write_b128 v0, v[200:203] offset:0
  ds_read_b64_tr_b16 v[196:197], v7 offset:0
  ds_read_b64_tr_b16 v[200:201], v8 offset:0
  s_waitcnt vmcnt(11)
  v_mfma_f32_32x32x16_bf16 v[76:91], v[68:71], v[36:39], v[76:91]
  ds_read_b64_tr_b16 v[60:61], v10 offset:8192
  ds_read_b64_tr_b16 v[62:63], v10 offset:9216
  ds_read_b64_tr_b16 v[64:65], v11 offset:8192
  ds_read_b64_tr_b16 v[66:67], v11 offset:9216
  v_mfma_f32_32x32x16_bf16 v[92:107], v[72:75], v[36:39], v[92:107]
  buffer_load_dwordx4 v[28:31], v2, s[32:35], s64 offen offset:1024 sc1
  buffer_load_dwordx4 v[32:35], v2, s[32:35], s65 offen offset:1024 sc1
  ds_write_b128 v0, v[204:207] offset:0
  ds_read_b64_tr_b16 v[198:199], v7 offset:0
  ds_read_b64_tr_b16 v[202:203], v8 offset:0
  s_waitcnt vmcnt(12)
  v_mfma_f32_32x32x16_bf16 v[108:123], v[68:71], v[40:43], v[108:123]
  v_mfma_f32_32x32x16_bf16 v[124:139], v[72:75], v[40:43], v[124:139]
  buffer_load_dwordx4 v[36:39], v2, s[32:35], s64 offen offset:2048 sc1
  buffer_load_dwordx4 v[40:43], v2, s[32:35], s65 offen offset:2048 sc1
  s_waitcnt vmcnt(13) lgkmcnt(5)
  v_mfma_f32_32x32x16_bf16 v[76:91], v[60:63], v[44:47], v[76:91]
  ds_read_b64_tr_b16 v[68:69], v10 offset:10240
  ds_read_b64_tr_b16 v[70:71], v10 offset:11264
  ds_read_b64_tr_b16 v[72:73], v11 offset:10240
  ds_read_b64_tr_b16 v[74:75], v11 offset:11264
  s_waitcnt lgkmcnt(7)
  v_mfma_f32_32x32x16_bf16 v[92:107], v[64:67], v[44:47], v[92:107]
  buffer_load_dwordx4 v[44:47], v2, s[32:35], s64 offen offset:3072 sc1
  ds_write_b128 v0, v[208:211] offset:0
  ds_read_b64_tr_b16 v[204:205], v7 offset:0
  ds_read_b64_tr_b16 v[208:209], v8 offset:0
  s_waitcnt vmcnt(13)
  v_mfma_f32_32x32x16_bf16 v[108:123], v[60:63], v[48:51], v[108:123]
  v_mfma_f32_32x32x16_bf16 v[124:139], v[64:67], v[48:51], v[124:139]
  buffer_load_dwordx4 v[48:51], v2, s[32:35], s65 offen offset:3072 sc1
  s_waitcnt vmcnt(13) lgkmcnt(5)
  v_mfma_f32_32x32x16_bf16 v[76:91], v[68:71], v[52:55], v[76:91]
  ds_read_b64_tr_b16 v[60:61], v10 offset:12288
  ds_read_b64_tr_b16 v[62:63], v10 offset:13312
  ds_read_b64_tr_b16 v[64:65], v11 offset:12288
  ds_read_b64_tr_b16 v[66:67], v11 offset:13312
  s_waitcnt lgkmcnt(7)
  v_mfma_f32_32x32x16_bf16 v[92:107], v[72:75], v[52:55], v[92:107]
  s_add_u32 s64, s66, 18432
  buffer_load_dwordx4 v[52:55], v2, s[32:35], s64 offen offset:0 sc1
  ds_write_b128 v0, v[212:215] offset:0
  ds_read_b64_tr_b16 v[206:207], v7 offset:0
  ds_read_b64_tr_b16 v[210:211], v8 offset:0
  s_waitcnt vmcnt(13)
  v_mfma_f32_32x32x16_bf16 v[108:123], v[68:71], v[56:59], v[108:123]
  v_mfma_f32_32x32x16_bf16 v[124:139], v[72:75], v[56:59], v[124:139]
  s_add_u32 s65, s66, 134144
  buffer_load_dwordx4 v[56:59], v2, s[32:35], s65 offen offset:0 sc1
  ds_write_b128 v0, v[216:219] offset:0
  ds_read_b64_tr_b16 v[212:213], v7 offset:0
  ds_read_b64_tr_b16 v[216:217], v8 offset:0
  s_waitcnt vmcnt(12) lgkmcnt(8)
  v_mfma_f32_32x32x16_bf16 v[76:91], v[60:63], v[12:15], v[76:91]
  ds_read_b64_tr_b16 v[68:69], v10 offset:14336
  ds_read_b64_tr_b16 v[70:71], v10 offset:15360
  ds_read_b64_tr_b16 v[72:73], v11 offset:14336
  ds_read_b64_tr_b16 v[74:75], v11 offset:15360
  s_waitcnt lgkmcnt(10)
  v_mfma_f32_32x32x16_bf16 v[92:107], v[64:67], v[12:15], v[92:107]
  buffer_load_dwordx4 v[12:15], v2, s[32:35], s64 offen offset:1024 sc1
  s_waitcnt vmcnt(12)
  v_mfma_f32_32x32x16_bf16 v[108:123], v[60:63], v[16:19], v[108:123]
  v_mfma_f32_32x32x16_bf16 v[124:139], v[64:67], v[16:19], v[124:139]
  buffer_load_dwordx4 v[16:19], v2, s[32:35], s65 offen offset:1024 sc1
  ds_write_b128 v0, v[220:223] offset:0
  ds_read_b64_tr_b16 v[214:215], v7 offset:0
  ds_read_b64_tr_b16 v[218:219], v8 offset:0
  s_waitcnt vmcnt(11) lgkmcnt(5)
  v_mfma_f32_32x32x16_bf16 v[76:91], v[68:71], v[20:23], v[76:91]
  ds_read_b64_tr_b16 v[60:61], v10 offset:16384
  ds_read_b64_tr_b16 v[62:63], v10 offset:17408
  ds_read_b64_tr_b16 v[64:65], v11 offset:16384
  ds_read_b64_tr_b16 v[66:67], v11 offset:17408
  s_waitcnt lgkmcnt(7)
  v_mfma_f32_32x32x16_bf16 v[92:107], v[72:75], v[20:23], v[92:107]
  buffer_load_dwordx4 v[20:23], v2, s[32:35], s64 offen offset:2048 sc1
  s_waitcnt vmcnt(11)
  v_mfma_f32_32x32x16_bf16 v[108:123], v[68:71], v[24:27], v[108:123]
  v_mfma_f32_32x32x16_bf16 v[124:139], v[72:75], v[24:27], v[124:139]
  buffer_load_dwordx4 v[24:27], v2, s[32:35], s65 offen offset:2048 sc1
  ds_write_b128 v0, v[224:227] offset:0
  ds_read_b64_tr_b16 v[220:221], v7 offset:0
  ds_read_b64_tr_b16 v[224:225], v8 offset:0
  s_waitcnt vmcnt(11) lgkmcnt(5)
  v_mfma_f32_32x32x16_bf16 v[76:91], v[60:63], v[28:31], v[76:91]
  ds_read_b64_tr_b16 v[68:69], v10 offset:18432
  ds_read_b64_tr_b16 v[70:71], v10 offset:19456
  ds_read_b64_tr_b16 v[72:73], v11 offset:18432
  ds_read_b64_tr_b16 v[74:75], v11 offset:19456
  s_waitcnt lgkmcnt(7)
  v_mfma_f32_32x32x16_bf16 v[92:107], v[64:67], v[28:31], v[92:107]
  ds_write_b128 v0, v[228:231] offset:0
  ds_read_b64_tr_b16 v[222:223], v7 offset:0
  ds_read_b64_tr_b16 v[226:227], v8 offset:0
  s_mov_b32 s13, 0
  s_atomic_add s13, s[22:23], s6 glc
  s_waitcnt vmcnt(10)
  v_mfma_f32_32x32x16_bf16 v[108:123], v[60:63], v[32:35], v[108:123]
  v_mfma_f32_32x32x16_bf16 v[124:139], v[64:67], v[32:35], v[124:139]
  s_waitcnt vmcnt(9) lgkmcnt(5)
  v_mfma_f32_32x32x16_bf16 v[76:91], v[68:71], v[36:39], v[76:91]
  ds_read_b64_tr_b16 v[60:61], v10 offset:20480
  ds_read_b64_tr_b16 v[62:63], v10 offset:21504
  ds_read_b64_tr_b16 v[64:65], v11 offset:20480
  ds_read_b64_tr_b16 v[66:67], v11 offset:21504
  s_waitcnt lgkmcnt(7)
  v_mfma_f32_32x32x16_bf16 v[92:107], v[72:75], v[36:39], v[92:107]
  ds_write_b128 v0, v[232:235] offset:0
  ds_read_b64_tr_b16 v[228:229], v7 offset:0
  ds_read_b64_tr_b16 v[232:233], v8 offset:0
  s_waitcnt vmcnt(8)
  v_mfma_f32_32x32x16_bf16 v[108:123], v[68:71], v[40:43], v[108:123]
  v_mfma_f32_32x32x16_bf16 v[124:139], v[72:75], v[40:43], v[124:139]
  ds_write_b128 v0, v[236:239] offset:0
  ds_read_b64_tr_b16 v[230:231], v7 offset:0
  ds_read_b64_tr_b16 v[234:235], v8 offset:0
  s_waitcnt vmcnt(7) lgkmcnt(8)
  v_mfma_f32_32x32x16_bf16 v[76:91], v[60:63], v[44:47], v[76:91]
  ds_read_b64_tr_b16 v[68:69], v10 offset:22528
  ds_read_b64_tr_b16 v[70:71], v10 offset:23552
  ds_read_b64_tr_b16 v[72:73], v11 offset:22528
  ds_read_b64_tr_b16 v[74:75], v11 offset:23552
  s_waitcnt lgkmcnt(10)
  v_mfma_f32_32x32x16_bf16 v[92:107], v[64:67], v[44:47], v[92:107]
  s_waitcnt vmcnt(6)
  v_mfma_f32_32x32x16_bf16 v[108:123], v[60:63], v[48:51], v[108:123]
  v_mfma_f32_32x32x16_bf16 v[124:139], v[64:67], v[48:51], v[124:139]
  ds_write_b128 v0, v[240:243] offset:0
  ds_read_b64_tr_b16 v[236:237], v7 offset:0
  ds_read_b64_tr_b16 v[240:241], v8 offset:0
  s_waitcnt lgkmcnt(0)
  s_cmp_ge_u32 s13, 14
  s_cbranch_scc0 L_y26
  s_add_u32 s6, s6, 8
  s_waitcnt vmcnt(5)
  v_mfma_f32_32x32x16_bf16 v[76:91], v[68:71], v[52:55], v[76:91]
  ds_read_b64_tr_b16 v[60:61], v10 offset:24576
  ds_read_b64_tr_b16 v[62:63], v10 offset:25600
  ds_read_b64_tr_b16 v[64:65], v11 offset:24576
  ds_read_b64_tr_b16 v[66:67], v11 offset:25600
  v_mfma_f32_32x32x16_bf16 v[92:107], v[72:75], v[52:55], v[92:107]
  s_add_u32 s64, s66, 57344
  buffer_load_dwordx4 v[28:31], v2, s[32:35], s64 offen offset:0 sc1
  buffer_load_dwordx4 v[32:35], v2, s[32:35], s64 offen offset:1024 sc1
  s_waitcnt vmcnt(6)
  v_mfma_f32_32x32x16_bf16 v[108:123], v[68:71], v[56:59], v[108:123]
  v_mfma_f32_32x32x16_bf16 v[124:139], v[72:75], v[56:59], v[124:139]
  buffer_load_dwordx4 v[36:39], v2, s[32:35], s64 offen offset:2048 sc1
  buffer_load_dwordx4 v[40:43], v2, s[32:35], s64 offen offset:3072 sc1
  ds_write_b128 v0, v[244:247] offset:0
  ds_read_b64_tr_b16 v[238:239], v7 offset:0
  ds_read_b64_tr_b16 v[242:243], v8 offset:0
  s_waitcnt vmcnt(7) lgkmcnt(5)
  v_mfma_f32_32x32x16_bf16 v[76:91], v[60:63], v[12:15], v[76:91]
  ds_read_b64_tr_b16 v[68:69], v10 offset:26624
  ds_read_b64_tr_b16 v[70:71], v10 offset:27648
  ds_read_b64_tr_b16 v[72:73], v11 offset:26624
  ds_read_b64_tr_b16 v[74:75], v11 offset:27648
  s_waitcnt lgkmcnt(7)
  v_mfma_f32_32x32x16_bf16 v[92:107], v[64:67], v[12:15], v[92:107]
  s_add_u32 s64, s66, 61440
  buffer_load_dwordx4 v[44:47], v2, s[32:35], s64 offen offset:0 sc1
  buffer_load_dwordx4 v[48:51], v2, s[32:35], s64 offen offset:1024 sc1
  ds_write_b128 v0, v[248:251] offset:0
  ds_read_b64_tr_b16 v[244:245], v7 offset:0
  ds_read_b64_tr_b16 v[248:249], v8 offset:0
  s_mov_b32 s13, 0
  s_atomic_add s13, s[22:23], s6 glc
  s_waitcnt vmcnt(8)
  v_mfma_f32_32x32x16_bf16 v[108:123], v[60:63], v[16:19], v[108:123]
  v_mfma_f32_32x32x16_bf16 v[124:139], v[64:67], v[16:19], v[124:139]
  buffer_load_dwordx4 v[52:55], v2, s[32:35], s64 offen offset:2048 sc1
  s_add_u32 s64, s66, 71680
  buffer_load_dwordx4 v[56:59], v2, s[32:35], s64 offen offset:0 sc1
  s_waitcnt vmcnt(9) lgkmcnt(5)
  v_mfma_f32_32x32x16_bf16 v[76:91], v[68:71], v[20:23], v[76:91]
  s_waitcnt lgkmcnt(3)
  v_mfma_f32_32x32x16_bf16 v[92:107], v[72:75], v[20:23], v[92:107]
  buffer_load_dwordx4 v[12:15], v2, s[32:35], s64 offen offset:1024 sc1
  buffer_load_dwordx4 v[16:19], v2, s[32:35], s64 offen offset:2048 sc1
  ds_write_b128 v0, v[252:255] offset:0
  ds_read_b64_tr_b16 v[246:247], v7 offset:0
  ds_read_b64_tr_b16 v[250:251], v8 offset:0
  s_waitcnt vmcnt(10)
  v_mfma_f32_32x32x16_bf16 v[108:123], v[68:71], v[24:27], v[108:123]
  v_mfma_f32_32x32x16_bf16 v[124:139], v[72:75], v[24:27], v[124:139]
  buffer_load_dwordx4 v[20:23], v2, s[32:35], s64 offen offset:3072 sc1
  s_add_u32 s64, s66, 75776
  buffer_load_dwordx4 v[24:27], v2, s[32:35], s64 offen offset:0 sc1
L_k27:
  s_setprio 0
  s_waitcnt vmcnt(11)
  v_mfma_f32_32x32x16_bf16 v[76:91], v[140:143], v[28:31], v[76:91]
  v_mfma_f32_32x32x16_bf16 v[92:107], v[144:147], v[28:31], v[92:107]
  buffer_load_dwordx4 v[28:31], v2, s[32:35], s64 offen offset:1024 sc1
  s_waitcnt vmcnt(11)
  v_mfma_f32_32x32x16_bf16 v[76:91], v[148:151], v[32:35], v[76:91]
  v_mfma_f32_32x32x16_bf16 v[92:107], v[152:155], v[32:35], v[92:107]
  s_waitcnt lgkmcnt(0)
  s_cmp_ge_u32 s13, 14
  s_cbranch_scc1 L_pf31
  s_mov_b32 s62, 0
L_poll32:
  s_mov_b32 s13, 0
  s_atomic_add s13, s[22:23], s6 glc
  s_add_u32 s62, s62, 1
  s_waitcnt lgkmcnt(0)
  s_cmp_gt_u32 s62, 0x8000
  s_cbranch_scc1 L_pend33
  s_cmp_lt_u32 s13, 14
  s_cbranch_scc1 L_poll32
L_pend33:
L_pf31:
  s_add_u32 s6, s6, 8
  buffer_load_dwordx4 v[32:35], v2, s[32:35], s64 offen offset:2048 sc1
  s_waitcnt vmcnt(11)
  v_mfma_f32_32x32x16_bf16 v[76:91], v[156:159], v[36:39], v[76:91]
  v_mfma_f32_32x32x16_bf16 v[92:107], v[160:163], v[36:39], v[92:107]
  s_add_u32 s65, s66, 173056
  buffer_load_dwordx4 v[36:39], v2, s[32:35], s65 offen offset:0 sc1
  s_waitcnt vmcnt(11)
  v_mfma_f32_32x32x16_bf16 v[76:91], v[164:167], v[40:43], v[76:91]
  v_mfma_f32_32x32x16_bf16 v[92:107], v[168:171], v[40:43], v[92:107]
  buffer_load_dwordx4 v[40:43], v2, s[32:35], s65 offen offset:1024 sc1
  s_waitcnt vmcnt(11)
  v_mfma_f32_32x32x16_bf16 v[76:91], v[172:175], v[44:47], v[76:91]
  v_mfma_f32_32x32x16_bf16 v[92:107], v[176:179], v[44:47], v[92:107]
  buffer_load_dwordx4 v[44:47], v2, s[32:35], s65 offen offset:2048 sc1
  s_waitcnt vmcnt(11)
  v_mfma_f32_32x32x16_bf16 v[76:91], v[180:183], v[48:51], v[76:91]
  v_mfma_f32_32x32x16_bf16 v[92:107], v[184:187], v[48:51], v[92:107]
  buffer_load_dwordx4 v[48:51], v2, s[32:35], s65 offen offset:3072 sc1
  s_waitcnt vmcnt(11)
  v_mfma_f32_32x32x16_bf16 v[76:91], v[188:191], v[52:55], v[76:91]
  v_mfma_f32_32x32x16_bf16 v[92:107], v[192:195], v[52:55], v[92:107]
  s_add_u32 s65, s66, 177152
  buffer_load_dwordx4 v[52:55], v2, s[32:35], s65 offen offset:0 sc1
  s_waitcnt vmcnt(11)
  v_mfma_f32_32x32x16_bf16 v[76:91], v[196:199], v[56:59], v[76:91]
  v_mfma_f32_32x32x16_bf16 v[92:107], v[200:203], v[56:59], v[92:107]
  buffer_load_dwordx4 v[56:59], v2, s[32:35], s65 offen offset:1024 sc1
  s_waitcnt vmcnt(11)
  v_mfma_f32_32x32x16_bf16 v[76:91], v[204:207], v[12:15], v[76:91]
  v_mfma_f32_32x32x16_bf16 v[92:107], v[208:211], v[12:15], v[92:107]
  buffer_load_dwordx4 v[12:15], v2, s[32:35], s65 offen offset:2048 sc1
  s_waitcnt vmcnt(11)
  v_mfma_f32_32x32x16_bf16 v[76:91], v[212:215], v[16:19], v[76:91]
  v_mfma_f32_32x32x16_bf16 v[92:107], v[216:219], v[16:19], v[92:107]
  s_add_u32 s65, s66, 187392
  buffer_load_dwordx4 v[16:19], v2, s[32:35], s65 offen offset:0 sc1
  s_waitcnt vmcnt(11)
  v_mfma_f32_32x32x16_bf16 v[76:91], v[220:223], v[20:23], v[76:91]
  v_mfma_f32_32x32x16_bf16 v[92:107], v[224:227], v[20:23], v[92:107]
  buffer_load_dwordx4 v[20:23], v2, s[32:35], s65 offen offset:1024 sc1
  s_waitcnt vmcnt(11)
  v_mfma_f32_32x32x16_bf16 v[76:91], v[228:231], v[24:27], v[76:91]
  v_mfma_f32_32x32x16_bf16 v[92:107], v[232:235], v[24:27], v[92:107]
  buffer_load_dwordx4 v[24:27], v2, s[32:35], s65 offen offset:2048 sc1
  s_waitcnt vmcnt(11)
  v_mfma_f32_32x32x16_bf16 v[76:91], v[236:239], v[28:31], v[76:91]
  v_mfma_f32_32x32x16_bf16 v[92:107], v[240:243], v[28:31], v[92:107]
  buffer_load_dwordx4 v[28:31], v2, s[32:35], s65 offen offset:3072 sc1
  s_waitcnt vmcnt(11)
  v_mfma_f32_32x32x16_bf16 v[76:91], v[244:247], v[32:35], v[76:91]
  v_mfma_f32_32x32x16_bf16 v[92:107], v[248:251], v[32:35], v[92:107]
  s_add_u32 s65, s66, 191488
  buffer_load_dwordx4 v[32:35], v2, s[32:35], s65 offen offset:0 sc1
  s_waitcnt vmcnt(11)
  v_mfma_f32_32x32x16_bf16 v[108:123], v[140:143], v[36:39], v[108:123]
  v_mfma_f32_32x32x16_bf16 v[124:139], v[144:147], v[36:39], v[124:139]
  buffer_load_dwordx4 v[36:39], v2, s[32:35], s65 offen offset:1024 sc1
  s_waitcnt vmcnt(11)
  v_mfma_f32_32x32x16_bf16 v[108:123], v[148:151], v[40:43], v[108:123]
  v_mfma_f32_32x32x16_bf16 v[124:139], v[152:155], v[40:43], v[124:139]
  buffer_load_dwordx4 v[40:43], v2, s[32:35], s65 offen offset:2048 sc1
  s_waitcnt vmcnt(11)
  v_mfma_f32_32x32x16_bf16 v[108:123], v[156:159], v[44:47], v[108:123]
  ds_write_b128 v3, v[76:79] offset:0
  v_mfma_f32_32x32x16_bf16 v[124:139], v[160:163], v[44:47], v[124:139]
  ds_write_b128 v4, v[80:83] offset:0
  s_waitcnt vmcnt(10)
  v_mfma_f32_32x32x16_bf16 v[108:123], v[164:167], v[48:51], v[108:123]
  ds_write_b128 v5, v[84:87] offset:0
  v_mfma_f32_32x32x16_bf16 v[124:139], v[168:171], v[48:51], v[124:139]
  ds_write_b128 v6, v[88:91] offset:0
  s_waitcnt vmcnt(9)
  v_mfma_f32_32x32x16_bf16 v[108:123], v[172:175], v[52:55], v[108:123]
  ds_write_b128 v3, v[92:95] offset:128
  v_mfma_f32_32x32x16_bf16 v[124:139], v[176:179], v[52:55], v[124:139]
  ds_write_b128 v4, v[96:99] offset:128
  s_waitcnt vmcnt(8)
  v_mfma_f32_32x32x16_bf16 v[108:123], v[180:183], v[56:59], v[108:123]
  ds_write_b128 v5, v[100:103] offset:128
  v_mfma_f32_32x32x16_bf16 v[124:139], v[184:187], v[56:59], v[124:139]
  ds_write_b128 v6, v[104:107] offset:128
  v_mov_b32 v8, 1800
  v_mov_b32 v7, 1
  s_mov_b64 exec, 1
  ds_add_u32 v8, v7
  s_mov_b64 exec, -1
  s_waitcnt vmcnt(7)
  v_mfma_f32_32x32x16_bf16 v[108:123], v[188:191], v[12:15], v[108:123]
  v_mfma_f32_32x32x16_bf16 v[124:139], v[192:195], v[12:15], v[124:139]
  s_waitcnt vmcnt(6)
  v_mfma_f32_32x32x16_bf16 v[108:123], v[196:199], v[16:19], v[108:123]
  v_mfma_f32_32x32x16_bf16 v[124:139], v[200:203], v[16:19], v[124:139]
  s_waitcnt vmcnt(5)
  v_mfma_f32_32x32x16_bf16 v[108:123], v[204:207], v[20:23], v[108:123]
  v_mfma_f32_32x32x16_bf16 v[124:139], v[208:211], v[20:23], v[124:139]
  s_waitcnt vmcnt(4)
  v_mfma_f32_32x32x16_bf16 v[108:123], v[212:215], v[24:27], v[108:123]
  s_waitcnt vmcnt(3)
  v_mfma_f32_32x32x16_bf16 v[108:123], v[220:223], v[28:31], v[108:123]
  s_waitcnt vmcnt(2)
  v_mfma_f32_32x32x16_bf16 v[108:123], v[228:231], v[32:35], v[108:123]
  s_waitcnt vmcnt(1)
  v_mfma_f32_32x32x16_bf16 v[108:123], v[236:239], v[36:39], v[108:123]
  s_waitcnt vmcnt(0)
  v_mfma_f32_32x32x16_bf16 v[108:123], v[244:247], v[40:43], v[108:123]
  v_mfma_f32_32x32x16_bf16 v[124:139], v[216:219], v[24:27], v[124:139]
  s_nop 4
  v_mfma_f32_32x32x16_bf16 v[124:139], v[224:227], v[28:31], v[124:139]
  s_nop 4
  v_mfma_f32_32x32x16_bf16 v[124:139], v[232:235], v[32:35], v[124:139]
  ds_write_b128 v3, v[108:111] offset:8192
  ds_write_b128 v4, v[112:115] offset:8192
  v_mfma_f32_32x32x16_bf16 v[124:139], v[240:243], v[36:39], v[124:139]
  ds_write_b128 v5, v[116:119] offset:8192
  ds_write_b128 v6, v[120:123] offset:8192
  v_mfma_f32_32x32x16_bf16 v[124:139], v[248:251], v[40:43], v[124:139]
  s_nop 11
  ds_write_b128 v3, v[124:127] offset:8320
  ds_write_b128 v4, v[128:131] offset:8320
  ds_write_b128 v5, v[132:135] offset:8320
  ds_write_b128 v6, v[136:139] offset:8320
  s_waitcnt lgkmcnt(0)
  s_barrier
  s_endpgm
L_y26:
  s_waitcnt vmcnt(5)
  v_mfma_f32_32x32x16_bf16 v[76:91], v[68:71], v[52:55], v[76:91]
  ds_read_b64_tr_b16 v[60:61], v10 offset:24576
  ds_read_b64_tr_b16 v[62:63], v10 offset:25600
  ds_read_b64_tr_b16 v[64:65], v11 offset:24576
  ds_read_b64_tr_b16 v[66:67], v11 offset:25600
  v_mfma_f32_32x32x16_bf16 v[92:107], v[72:75], v[52:55], v[92:107]
  s_mov_b32 s13, 0
  s_atomic_add s13, s[22:23], s6 glc
  s_waitcnt vmcnt(4)
  v_mfma_f32_32x32x16_bf16 v[108:123], v[68:71], v[56:59], v[108:123]
  v_mfma_f32_32x32x16_bf16 v[124:139], v[72:75], v[56:59], v[124:139]
  ds_write_b128 v0, v[244:247] offset:0
  ds_read_b64_tr_b16 v[238:239], v7 offset:0
  ds_read_b64_tr_b16 v[242:243], v8 offset:0
  s_waitcnt vmcnt(3) lgkmcnt(5)
  v_mfma_f32_32x32x16_bf16 v[76:91], v[60:63], v[12:15], v[76:91]
  ds_read_b64_tr_b16 v[68:69], v10 offset:26624
  ds_read_b64_tr_b16 v[70:71], v10 offset:27648
  ds_read_b64_tr_b16 v[72:73], v11 offset:26624
  ds_read_b64_tr_b16 v[74:75], v11 offset:27648
  s_waitcnt lgkmcnt(7)
  v_mfma_f32_32x32x16_bf16 v[92:107], v[64:67], v[12:15], v[92:107]
  ds_write_b128 v0, v[248:251] offset:0
  ds_read_b64_tr_b16 v[244:245], v7 offset:0
  ds_read_b64_tr_b16 v[248:249], v8 offset:0
  s_waitcnt vmcnt(2)
  v_mfma_f32_32x32x16_bf16 v[108:123], v[60:63], v[16:19], v[108:123]
  v_mfma_f32_32x32x16_bf16 v[124:139], v[64:67], v[16:19], v[124:139]
  s_waitcnt vmcnt(1) lgkmcnt(5)
  v_mfma_f32_32x32x16_bf16 v[76:91], v[68:71], v[20:23], v[76:91]
  s_waitcnt lgkmcnt(3)
  v_mfma_f32_32x32x16_bf16 v[92:107], v[72:75], v[20:23], v[92:107]
  ds_write_b128 v0, v[252:255] offset:0
  ds_read_b64_tr_b16 v[246:247], v7 offset:0
  ds_read_b64_tr_b16 v[250:251], v8 offset:0
  s_waitcnt vmcnt(0)
  v_mfma_f32_32x32x16_bf16 v[108:123], v[68:71], v[24:27], v[108:123]
  v_mfma_f32_32x32x16_bf16 v[124:139], v[72:75], v[24:27], v[124:139]
  s_waitcnt lgkmcnt(0)
  s_cmp_ge_u32 s13, 14
  s_cbranch_scc1 L_pf28
  s_mov_b32 s62, 0
L_poll29:
  s_mov_b32 s13, 0
  s_atomic_add s13, s[22:23], s6 glc
  s_add_u32 s62, s62, 1
  s_waitcnt lgkmcnt(0)
  s_cmp_gt_u32 s62, 0x8000
  s_cbranch_scc1 L_pend30
  s_cmp_lt_u32 s13, 14
  s_cbranch_scc1 L_poll29
L_pend30:
L_pf28:
  s_add_u32 s6, s6, 8
  s_add_u32 s64, s66, 57344
  buffer_load_dwordx4 v[28:31], v2, s[32:35], s64 offen offset:0 sc1
  buffer_load_dwordx4 v[32:35], v2, s[32:35], s64 offen offset:1024 sc1
  buffer_load_dwordx4 v[36:39], v2, s[32:35], s64 offen offset:2048 sc1
  buffer_load_dwordx4 v[40:43], v2, s[32:35], s64 offen offset:3072 sc1
  s_add_u32 s64, s66, 61440
  buffer_load_dwordx4 v[44:47], v2, s[32:35], s64 offen offset:0 sc1
  buffer_load_dwordx4 v[48:51], v2, s[32:35], s64 offen offset:1024 sc1
  s_mov_b32 s13, 0
  s_atomic_add s13, s[22:23], s6 glc
  buffer_load_dwordx4 v[52:55], v2, s[32:35], s64 offen offset:2048 sc1
  s_add_u32 s64, s66, 71680
  buffer_load_dwordx4 v[56:59], v2, s[32:35], s64 offen offset:0 sc1
  buffer_load_dwordx4 v[12:15], v2, s[32:35], s64 offen offset:1024 sc1
  buffer_load_dwordx4 v[16:19], v2, s[32:35], s64 offen offset:2048 sc1
  buffer_load_dwordx4 v[20:23], v2, s[32:35], s64 offen offset:3072 sc1
  s_add_u32 s64, s66, 75776
  buffer_load_dwordx4 v[24:27], v2, s[32:35], s64 offen offset:0 sc1
  s_branch L_k27
L_spare:
  s_and_b32 s49, s48, 3
  s_min_u32 s53, s48, 6
  s_lshr_b32 s56, s2, 4
  s_lshl_b32 s56, s56, 3
  s_and_b32 s50, s2, 7
  s_add_u32 s50, s50, s56
  s_bfe_u32 s55, s2, 0x10003
  s_sub_u32 s63, 32, s50
  s_cmp_eq_u32 s50, 0
  s_cselect_b32 s63, 16, s63
  v_mov_b32 v3, 139200
  v_mov_b64 v[12:13], 0
  ds_write_b64 v3, v[12:13]
  ds_write_b64 v3, v[12:13] offset:8
  s_waitcnt lgkmcnt(0)
  s_barrier
  s_mov_b32 s32, s22
  s_and_b32 s33, s23, 0xffff
  s_mov_b32 s34, 17825792
  s_mov_b32 s35, 0x20000
  s_mov_b32 s44, s20
  s_and_b32 s45, s21, 0xffff
  s_mov_b32 s46, 256
  s_mov_b32 s47, 0x20000
  s_cmp_lt_u32 s48, 4
  s_cbranch_scc0 L_sk34
  v_mov_b32 v14, 0
  v_mov_b32 v15, 0
  s_mul_i32 s56, s2, 2304
  s_add_u32 s56, s56, 11141120
  s_mul_i32 s57, s2, 7
  s_add_u32 s57, s57, s48
  s_lshl_b32 s57, s57, 10
  s_add_u32 s57, s57, 11231232
  buffer_store_dwordx4 v[12:15], v2, s[32:35], s57 offen sc1
  s_add_u32 s57, s57, 4096
  v_lshrrev_b32 v3, 1, v1
  v_and_b32 v4, 16, v2
  v_lshl_add_u32 v3, v3, 7, v4
  s_cmp_eq_u32 s48, 3
  s_cselect_b32 s56, s56, s57
  s_cselect_b64 vcc, -1, 0
  s_cselect_b32 exec_hi, 0xf, -1
  v_cndmask_b32 v3, v2, v3, vcc
  buffer_store_dwordx4 v[12:15], v3, s[32:35], s56 offen sc1
  s_mov_b64 exec, -1
L_sk34:
  s_cmp_ge_u32 s48, 4
  s_cbranch_scc0 L_sk35
  s_cmp_lt_u32 s49, 2
  s_cselect_b32 s24, s6, s8
  s_cselect_b32 s25, s7, s9
  s_and_b32 s25, s25, 0xffff
  s_mov_b32 s26, 921600
  s_mov_b32 s27, 0x20000
  s_min_u32 s59, s50, 1
  s_and_b32 s59, s59, s49
  s_bitcmp1_b32 s49, 0
  s_cselect_b32 s58, s63, s50
  s_cselect_b32 s51, 2, 0
  s_mul_i32 s68, s58, 450
  s_mul_i32 s56, s59, 14400
  s_sub_u32 s69, s68, s56
  v_bfe_u32 v3, v1, 4, 1
  v_or_b32 v3, s51, v3
  v_xor_b32 v3, v3, v1
  v_and_b32 v3, 7, v3
  v_xor_b32 v5, 4, v3
  v_cmp_ne_u32 s[64:65], 7, v3
  v_cmp_ne_u32 s[66:67], 7, v5
  s_mul_i32 s56, s55, 7
  v_add_lshl_u32 v3, v3, s56, 4
  v_add_lshl_u32 v5, v5, s56, 4
  v_add_u32 v3, 2, v3
  v_sub_u32 v5, 432, v5
  v_lshrrev_b32 v4, 3, v1
  s_movk_i32 s56, 14400
  v_mad_u32_u24 v224, v4, s56, v3
  v_mad_u32_u24 v225, v4, s56, v5
  v_subrev_u32 v4, s59, v4
  v_and_b32 v4, 63, v4
  v_mad_u32_u24 v226, v4, s56, v3
  v_mad_u32_u24 v227, v4, s56, v5
  v_subrev_u32 v7, s59, v1
  v_and_b32 v7, 63, v7
  v_mul_u32_u24 v7, 14400, v7
  s_lshl_b32 s58, s49, 14
  s_add_u32 s56, s69, 0
  s_add_u32 m0, s58, 0
  s_mov_b64 exec, s[64:65]
  buffer_load_dwordx4 v226, s[24:27], s68 offen  lds
  s_add_u32 m0, s58, 8192
  s_mov_b64 exec, s[66:67]
  buffer_load_dwordx4 v227, s[24:27], s68 offen  lds
  s_add_u32 s56, s69, 115200
  s_add_u32 m0, s58, 1024
  s_mov_b64 exec, s[64:65]
  buffer_load_dwordx4 v224, s[24:27], s56 offen  lds
  s_add_u32 m0, s58, 9216
  s_mov_b64 exec, s[66:67]
  buffer_load_dwordx4 v225, s[24:27], s56 offen  lds
  s_add_u32 s56, s69, 230400
  s_add_u32 m0, s58, 2048
  s_mov_b64 exec, s[64:65]
  buffer_load_dwordx4 v224, s[24:27], s56 offen  lds
  s_add_u32 m0, s58, 10240
  s_mov_b64 exec, s[66:67]
  buffer_load_dwordx4 v225, s[24:27], s56 offen  lds
  s_add_u32 s56, s69, 345600
  s_add_u32 m0, s58, 3072
  s_mov_b64 exec, s[64:65]
  buffer_load_dwordx4 v224, s[24:27], s56 offen  lds
  s_add_u32 m0, s58, 11264
  s_mov_b64 exec, s[66:67]
  buffer_load_dwordx4 v225, s[24:27], s56 offen  lds
  s_add_u32 s56, s69, 460800
  s_add_u32 m0, s58, 4096
  s_mov_b64 exec, s[64:65]
  buffer_load_dwordx4 v224, s[24:27], s56 offen  lds
  s_add_u32 m0, s58, 12288
  s_mov_b64 exec, s[66:67]
  buffer_load_dwordx4 v225, s[24:27], s56 offen  lds
  s_add_u32 s56, s69, 576000
  s_add_u32 m0, s58, 5120
  s_mov_b64 exec, s[64:65]
  buffer_load_dwordx4 v224, s[24:27], s56 offen  lds
  s_add_u32 m0, s58, 13312
  s_mov_b64 exec, s[66:67]
  buffer_load_dwordx4 v225, s[24:27], s56 offen  lds
  s_add_u32 s56, s69, 691200
  s_add_u32 m0, s58, 6144
  s_mov_b64 exec, s[64:65]
  buffer_load_dwordx4 v224, s[24:27], s56 offen  lds
  s_add_u32 m0, s58, 14336
  s_mov_b64 exec, s[66:67]
  buffer_load_dwordx4 v225, s[24:27], s56 offen  lds
  s_add_u32 s56, s69, 806400
  s_add_u32 m0, s58, 7168
  s_mov_b64 exec, s[64:65]
  buffer_load_dwordx4 v224, s[24:27], s56 offen  lds
  s_add_u32 m0, s58, 15360
  s_mov_b64 exec, s[66:67]
  buffer_load_dwordx4 v225, s[24:27], s56 offen  lds
  s_mov_b64 exec, -1
  s_cmp_eq_u32 s55, 1
  s_cbranch_scc0 L_sk36
  buffer_load_ushort v8, v7, s[24:27], s68 offen offset:448
L_sk36:
  v_bfe_u32 v3, v1, 1, 1
  v_or_b32 v3, s51, v3
  v_xor_b32 v3, 2, v3
  v_lshl_add_u32 v3, v3, 4, s58
  v_lshl_add_u32 v7, v1, 7, v3
L_sk35:
  s_mov_b32 s36, s16
  s_and_b32 s37, s17, 0xffff
  s_mov_b32 s38, 1605632
  s_mov_b32 s39, 0x20000
  s_cmp_lt_u32 s49, 2
  s_cselect_b32 s28, s12, s14
  s_cselect_b32 s29, s13, s15
  s_and_b32 s29, s29, 0xffff
  s_mov_b32 s30, 1605632
  s_mov_b32 s31, 0x20000
  s_and_b32 s56, s2, 30
  s_and_b32 s57, s49, 1
  s_add_u32 s56, s56, s57
  s_mul_i32 s61, s56, 50176
  s_and_b32 s56, s2, 1
  s_mul_i32 s56, s56, 1792
  s_add_u32 s61, s61, s56
  s_add_u32 s68, s61, 25088
  v_lshrrev_b32 v3, 3, v1
  v_min_u32 v3, 6, v3
  v_and_b32 v4, 7, v1
  v_min_u32 v4, 6, v4
  v_mul_u32_u24 v248, 3584, v3
  v_lshl_add_u32 v248, v4, 8, v248
  s_lshl_b32 s56, s2, 2
  s_add_u32 s56, s56, s49
  s_mul_i32 s56, s56, 7
  v_add_u32 v3, s56, v3
  v_and_b32 v5, 0x3c0, v3
  v_add_u32 v3, v3, v5
  v_mul_u32_u24 v249, 896, v3
  v_lshl_add_u32 v249, v4, 7, v249
  s_mov_b32 s51, 57344
  s_cmp_lt_u32 s48, 4
  s_cbranch_scc0 L_sk37
  buffer_load_dword v250, v248, s[28:31], s61 offen offset:0
  buffer_load_dword v250, v248, s[28:31], s68 offen offset:0
  v_cvt_f32_u32 v3, v10
  s_and_b32 s58, s49, 1
  s_lshl_b32 s57, s58, 5
  s_cmp_lt_u32 s49, 2
  s_cselect_b32 s66, 0, s57
  s_cselect_b32 s67, s57, 0
  s_cselect_b32 s59, 1.0, 0x36124925
  v_cvt_f32_u32 v4, s66
  v_cvt_f32_u32 v5, s67
  v_mul_f32 v5, v5, v3
  v_fmamk_f32 v3, v3, 0x42800000, v4
  v_mul_f32 v3, 0x3a000000, v3
  v_mul_f32 v5, 0x3a000000, v5
  v_lshlrev_b32 v4, 2, v9
  v_cvt_f32_u32 v4, v4
  v_fma_f32 v4, v4, v3, v5
  s_lshl_b32 s56, s49, 11
  s_add_u32 s56, s56, 139264
  v_add_u32 v5, s56, v2
  v_fmamk_f32 v76, v3, 0x00000000, v4
  v_fmamk_f32 v77, v3, 0x3f800000, v4
  v_fmamk_f32 v78, v3, 0x40000000, v4
  v_fmamk_f32 v79, v3, 0x40400000, v4
  v_fmamk_f32 v80, v3, 0x41000000, v4
  v_fmamk_f32 v81, v3, 0x41100000, v4
  v_fmamk_f32 v82, v3, 0x41200000, v4
  v_fmamk_f32 v83, v3, 0x41300000, v4
  v_sin_f32 v84, v76
  v_sin_f32 v85, v77
  v_sin_f32 v86, v78
  v_sin_f32 v87, v79
  v_sin_f32 v88, v80
  v_sin_f32 v89, v81
  v_sin_f32 v90, v82
  v_sin_f32 v91, v83
  v_cos_f32 v76, v76
  v_cos_f32 v77, v77
  v_cos_f32 v78, v78
  v_cos_f32 v79, v79
  v_cos_f32 v80, v80
  v_cos_f32 v81, v81
  v_cos_f32 v82, v82
  v_cos_f32 v83, v83
  v_mul_f32 v84, s59, v84
  v_mul_f32 v85, s59, v85
  v_mul_f32 v86, s59, v86
  v_mul_f32 v87, s59, v87
  v_mul_f32 v88, s59, v88
  v_mul_f32 v89, s59, v89
  v_mul_f32 v90, s59, v90
  v_mul_f32 v91, s59, v91
  v_mul_f32 v76, s59, v76
  v_mul_f32 v77, s59, v77
  v_mul_f32 v78, s59, v78
  v_mul_f32 v79, s59, v79
  v_mul_f32 v80, s59, v80
  v_mul_f32 v81, s59, v81
  v_mul_f32 v82, s59, v82
  v_mul_f32 v83, s59, v83
  v_cvt_pk_bf16_f32 v172, v76, v77
  v_cvt_pk_bf16_f32 v173, v78, v79
  v_cvt_pk_bf16_f32 v174, v80, v81
  v_cvt_pk_bf16_f32 v175, v82, v83
  v_cvt_pk_bf16_f32 v176, v84, v85
  v_cvt_pk_bf16_f32 v177, v86, v87
  v_cvt_pk_bf16_f32 v178, v88, v89
  v_cvt_pk_bf16_f32 v179, v90, v91
  v_xor_b32 v180, 0x80008000, v176
  v_xor_b32 v181, 0x80008000, v177
  v_xor_b32 v182, 0x80008000, v178
  v_xor_b32 v183, 0x80008000, v179
  ds_write_b128 v5, v[172:175] offset:0
  ds_write_b128 v5, v[176:179] offset:8192
  ds_write_b128 v5, v[180:183] offset:16384
  v_fmamk_f32 v76, v3, 0x41800000, v4
  v_fmamk_f32 v77, v3, 0x41880000, v4
  v_fmamk_f32 v78, v3, 0x41900000, v4
  v_fmamk_f32 v79, v3, 0x41980000, v4
  v_fmamk_f32 v80, v3, 0x41c00000, v4
  v_fmamk_f32 v81, v3, 0x41c80000, v4
  v_fmamk_f32 v82, v3, 0x41d00000, v4
  v_fmamk_f32 v83, v3, 0x41d80000, v4
  v_sin_f32 v84, v76
  v_sin_f32 v85, v77
  v_sin_f32 v86, v78
  v_sin_f32 v87, v79
  v_sin_f32 v88, v80
  v_sin_f32 v89, v81
  v_sin_f32 v90, v82
  v_sin_f32 v91, v83
  v_cos_f32 v76, v76
  v_cos_f32 v77, v77
  v_cos_f32 v78, v78
  v_cos_f32 v79, v79
  v_cos_f32 v80, v80
  v_cos_f32 v81, v81
  v_cos_f32 v82, v82
  v_cos_f32 v83, v83
  v_mul_f32 v84, s59, v84
  v_mul_f32 v85, s59, v85
  v_mul_f32 v86, s59, v86
  v_mul_f32 v87, s59, v87
  v_mul_f32 v88, s59, v88
  v_mul_f32 v89, s59, v89
  v_mul_f32 v90, s59, v90
  v_mul_f32 v91, s59, v91
  v_mul_f32 v76, s59, v76
  v_mul_f32 v77, s59, v77
  v_mul_f32 v78, s59, v78
  v_mul_f32 v79, s59, v79
  v_mul_f32 v80, s59, v80
  v_mul_f32 v81, s59, v81
  v_mul_f32 v82, s59, v82
  v_mul_f32 v83, s59, v83
  v_cvt_pk_bf16_f32 v172, v76, v77
  v_cvt_pk_bf16_f32 v173, v78, v79
  v_cvt_pk_bf16_f32 v174, v80, v81
  v_cvt_pk_bf16_f32 v175, v82, v83
  v_cvt_pk_bf16_f32 v176, v84, v85
  v_cvt_pk_bf16_f32 v177, v86, v87
  v_cvt_pk_bf16_f32 v178, v88, v89
  v_cvt_pk_bf16_f32 v179, v90, v91
  v_xor_b32 v180, 0x80008000, v176
  v_xor_b32 v181, 0x80008000, v177
  v_xor_b32 v182, 0x80008000, v178
  v_xor_b32 v183, 0x80008000, v179
  ds_write_b128 v5, v[172:175] offset:1024
  ds_write_b128 v5, v[176:179] offset:9216
  ds_write_b128 v5, v[180:183] offset:17408
  v_mov_b32 v4, 139200
  v_mov_b32 v3, 1
  s_waitcnt vmcnt(2)
  s_mov_b64 exec, 1
  ds_add_rtn_u32 v4, v4, v3
  s_waitcnt lgkmcnt(0)
  v_cmp_eq_u32 vcc, 3, v4
  s_mov_b64 exec, -1
  s_cbranch_vccz L_cl38
  s_mov_b32 s10, 1
  s_atomic_add s10, s[20:21], 0x0
L_cl38:
L_sk37:
  s_mul_i32 s52, s55, 7
  s_add_u32 s52, s52, s53
  v_bfe_u32 v3, v1, 3, 2
  v_bfe_u32 v4, v1, 1, 1
  v_lshl_or_b32 v3, v4, 2, v3
  v_xor_b32 v3, s53, v3
  v_lshlrev_b32 v3, 4, v3
  v_lshl_add_u32 v3, v4, 13, v3
  v_xor_b32 v4, v4, v1
  v_and_b32 v4, 1, v4
  v_lshl_add_u32 v3, v4, 3, v3
  v_bfe_u32 v4, v1, 2, 2
  v_lshl_add_u32 v3, v4, 7, v3
  v_lshl_add_u32 v3, v9, 9, v3
  v_bfe_u32 v4, v1, 4, 1
  v_lshl_add_u32 v6, v4, 14, v3
  s_lshl_b32 s62, s53, 13
  s_add_u32 s60, s62, 65536
  v_bfe_u32 v3, v1, 3, 1
  v_bfe_u32 v4, v1, 4, 1
  v_lshl_or_b32 v3, v4, 1, v3
  v_lshlrev_b32 v3, 5, v3
  v_bfe_u32 v4, v1, 2, 2
  v_lshl_add_u32 v3, v4, 7, v3
  v_lshl_add_u32 v3, v9, 9, v3
  v_and_b32 v4, 3, v1
  v_lshl_add_u32 v3, v4, 3, v3
  v_add_u32 v210, s60, v3
  v_xor_b32 v211, 32, v210
  v_add_u32 v208, 139264, v2
  v_bfe_u32 v4, v1, 4, 1
  v_lshlrev_b32 v4, 5, v4
  v_xor_b32 v212, v4, v2
  s_mov_b32 s56, 57344
  v_lshrrev_b32 v3, 3, v1
  v_and_b32 v4, 0x70, v2
  v_mad_u32_u24 v213, v3, s56, v4
  v_lshlrev_b32 v3, 4, v3
  v_xor_b32 v3, v3, v2
  v_add_u32 v220, s60, v3
  v_and_b32 v3, 7, v10
  v_xor_b32 v3, v3, v9
  v_lshlrev_b32 v3, 4, v3
  v_lshl_add_u32 v3, v10, 7, v3
  v_add_u32 v216, s60, v3
  v_xor_b32 v217, 32, v216
  v_xor_b32 v218, 64, v216
  v_xor_b32 v219, 96, v216
  s_mul_i32 s56, s50, 14
  s_add_u32 s56, s56, s52
  s_lshl_b32 s56, s56, 13
  s_add_u32 s69, s56, 7471104
  s_lshl_b32 s56, s52, 4
  s_add_u32 s56, s56, s50
  s_lshl_b32 s56, s56, 7
  s_add_u32 s64, s56, 9306112
  s_and_b32 s56, s2, 7
  s_mul_i32 s56, s56, 14
  s_add_u32 s56, s56, s52
  s_lshl_b32 s56, s56, 7
  s_add_u32 s65, s56, 11169792
  s_mul_i32 s56, s49, 7168
  s_add_u32 s56, s56, 11184128
  v_lshl_add_u32 v209, v1, 7, s56
  v_cvt_f32_u32 v3, v10
  v_mul_f32 v3, 0x3c800000, v3
  v_add_f32 v4, 0x3c000000, v3
  v_cos_f32 v240, v3
  v_sin_f32 v242, v3
  v_cos_f32 v244, v4
  v_sin_f32 v246, v4
  v_mov_b32 v241, v240
  v_mov_b32 v243, v242
  v_mov_b32 v245, v244
  v_mov_b32 v247, v246
  s_barrier
  s_cmp_lt_u32 s48, 4
  s_cbranch_scc0 L_sk39
  buffer_load_dword v5, off, s[44:47], 0 sc1
  s_mov_b32 s62, 0
  s_waitcnt vmcnt(0)
L_chk40:
  v_cmp_gt_u32 vcc, 32, v5
  s_cbranch_vccz L_cend41
  s_add_u32 s62, s62, 1
  s_cmp_gt_u32 s62, 0x8000
  s_cbranch_scc1 L_cend41
  buffer_load_dword v5, off, s[44:47], 0 sc1
  s_waitcnt vmcnt(0)
  s_branch L_chk40
L_cend41:
L_sk39:
  s_cmp_ge_u32 s48, 4
  s_cbranch_scc0 L_sk42
  s_waitcnt vmcnt(0)
  s_cmp_eq_u32 s55, 1
  s_cbranch_scc0 L_sk43
  ds_write_b16 v7, v8 offset:8192
L_sk43:
L_sk42:
  s_waitcnt lgkmcnt(0)
  s_barrier
  ds_read_b64_tr_b16 v[76:77], v6 offset:0
  ds_read_b64_tr_b16 v[78:79], v6 offset:4096
  ds_read_b64_tr_b16 v[80:81], v6 offset:1024
  ds_read_b64_tr_b16 v[82:83], v6 offset:5120
  ds_read_b64_tr_b16 v[84:85], v6 offset:2048
  ds_read_b64_tr_b16 v[86:87], v6 offset:6144
  ds_read_b64_tr_b16 v[88:89], v6 offset:3072
  ds_read_b64_tr_b16 v[90:91], v6 offset:7168
  ds_read_b64_tr_b16 v[92:93], v6 offset:32768
  ds_read_b64_tr_b16 v[94:95], v6 offset:36864
  ds_read_b64_tr_b16 v[96:97], v6 offset:33792
  ds_read_b64_tr_b16 v[98:99], v6 offset:37888
  ds_read_b64_tr_b16 v[100:101], v6 offset:34816
  ds_read_b64_tr_b16 v[102:103], v6 offset:38912
  ds_read_b64_tr_b16 v[104:105], v6 offset:35840
  ds_read_b64_tr_b16 v[106:107], v6 offset:39936
  s_cmp_ge_u32 s48, 4
  s_cbranch_scc0 L_sk44
L_sk44:
  s_waitcnt lgkmcnt(15)
  v_lshlrev_b32 v224, 16, v76
  v_and_b32 v225, 0xffff0000, v76
  s_waitcnt lgkmcnt(14)
  v_lshlrev_b32 v226, 16, v78
  v_and_b32 v227, 0xffff0000, v78
  v_pk_add_f32 v[12:13], v[224:225], v[226:227]
  v_pk_add_f32 v[28:29], v[224:225], v[226:227] neg_lo:[0,1] neg_hi:[0,1]
  v_lshlrev_b32 v228, 16, v77
  v_and_b32 v229, 0xffff0000, v77
  v_lshlrev_b32 v230, 16, v79
  v_and_b32 v231, 0xffff0000, v79
  v_pk_add_f32 v[14:15], v[228:229], v[230:231]
  v_pk_add_f32 v[30:31], v[228:229], v[230:231] neg_lo:[0,1] neg_hi:[0,1]
  s_waitcnt lgkmcnt(13)
  v_lshlrev_b32 v224, 16, v80
  v_and_b32 v225, 0xffff0000, v80
  s_waitcnt lgkmcnt(12)
  v_lshlrev_b32 v226, 16, v82
  v_and_b32 v227, 0xffff0000, v82
  v_pk_add_f32 v[16:17], v[224:225], v[226:227]
  v_pk_add_f32 v[32:33], v[224:225], v[226:227] neg_lo:[0,1] neg_hi:[0,1]
  v_lshlrev_b32 v228, 16, v81
  v_and_b32 v229, 0xffff0000, v81
  v_lshlrev_b32 v230, 16, v83
  v_and_b32 v231, 0xffff0000, v83
  v_pk_add_f32 v[18:19], v[228:229], v[230:231]
  v_pk_add_f32 v[34:35], v[228:229], v[230:231] neg_lo:[0,1] neg_hi:[0,1]
  s_waitcnt lgkmcnt(11)
  v_lshlrev_b32 v224, 16, v84
  v_and_b32 v225, 0xffff0000, v84
  s_waitcnt lgkmcnt(10)
  v_lshlrev_b32 v226, 16, v86
  v_and_b32 v227, 0xffff0000, v86
  v_pk_add_f32 v[20:21], v[224:225], v[226:227]
  v_pk_add_f32 v[36:37], v[224:225], v[226:227] neg_lo:[0,1] neg_hi:[0,1]
  v_lshlrev_b32 v228, 16, v85
  v_and_b32 v229, 0xffff0000, v85
  v_lshlrev_b32 v230, 16, v87
  v_and_b32 v231, 0xffff0000, v87
  v_pk_add_f32 v[22:23], v[228:229], v[230:231]
  v_pk_add_f32 v[38:39], v[228:229], v[230:231] neg_lo:[0,1] neg_hi:[0,1]
  s_waitcnt lgkmcnt(9)
  v_lshlrev_b32 v224, 16, v88
  v_and_b32 v225, 0xffff0000, v88
  s_waitcnt lgkmcnt(8)
  v_lshlrev_b32 v226, 16, v90
  v_and_b32 v227, 0xffff0000, v90
  v_pk_add_f32 v[24:25], v[224:225], v[226:227]
  v_pk_add_f32 v[40:41], v[224:225], v[226:227] neg_lo:[0,1] neg_hi:[0,1]
  v_lshlrev_b32 v228, 16, v89
  v_and_b32 v229, 0xffff0000, v89
  v_lshlrev_b32 v230, 16, v91
  v_and_b32 v231, 0xffff0000, v91
  v_pk_add_f32 v[26:27], v[228:229], v[230:231]
  v_pk_add_f32 v[42:43], v[228:229], v[230:231] neg_lo:[0,1] neg_hi:[0,1]
  s_waitcnt lgkmcnt(7)
  v_lshlrev_b32 v224, 16, v92
  v_and_b32 v225, 0xffff0000, v92
  s_waitcnt lgkmcnt(6)
  v_lshlrev_b32 v226, 16, v94
  v_and_b32 v227, 0xffff0000, v94
  v_pk_add_f32 v[44:45], v[224:225], v[226:227]
  v_pk_add_f32 v[60:61], v[224:225], v[226:227] neg_lo:[0,1] neg_hi:[0,1]
  v_lshlrev_b32 v228, 16, v93
  v_and_b32 v229, 0xffff0000, v93
  v_lshlrev_b32 v230, 16, v95
  v_and_b32 v231, 0xffff0000, v95
  v_pk_add_f32 v[46:47], v[228:229], v[230:231]
  v_pk_add_f32 v[62:63], v[228:229], v[230:231] neg_lo:[0,1] neg_hi:[0,1]
  s_waitcnt lgkmcnt(5)
  v_lshlrev_b32 v224, 16, v96
  v_and_b32 v225, 0xffff0000, v96
  s_waitcnt lgkmcnt(4)
  v_lshlrev_b32 v226, 16, v98
  v_and_b32 v227, 0xffff0000, v98
  v_pk_add_f32 v[48:49], v[224:225], v[226:227]
  v_pk_add_f32 v[64:65], v[224:225], v[226:227] neg_lo:[0,1] neg_hi:[0,1]
  v_lshlrev_b32 v228, 16, v97
  v_and_b32 v229, 0xffff0000, v97
  v_lshlrev_b32 v230, 16, v99
  v_and_b32 v231, 0xffff0000, v99
  v_pk_add_f32 v[50:51], v[228:229], v[230:231]
  v_pk_add_f32 v[66:67], v[228:229], v[230:231] neg_lo:[0,1] neg_hi:[0,1]
  s_waitcnt lgkmcnt(3)
  v_lshlrev_b32 v224, 16, v100
  v_and_b32 v225, 0xffff0000, v100
  s_waitcnt lgkmcnt(2)
  v_lshlrev_b32 v226, 16, v102
  v_and_b32 v227, 0xffff0000, v102
  v_pk_add_f32 v[52:53], v[224:225], v[226:227]
  v_pk_add_f32 v[68:69], v[224:225], v[226:227] neg_lo:[0,1] neg_hi:[0,1]
  v_lshlrev_b32 v228, 16, v101
  v_and_b32 v229, 0xffff0000, v101
  v_lshlrev_b32 v230, 16, v103
  v_and_b32 v231, 0xffff0000, v103
  v_pk_add_f32 v[54:55], v[228:229], v[230:231]
  v_pk_add_f32 v[70:71], v[228:229], v[230:231] neg_lo:[0,1] neg_hi:[0,1]
  s_waitcnt lgkmcnt(1)
  v_lshlrev_b32 v224, 16, v104
  v_and_b32 v225, 0xffff0000, v104
  s_waitcnt lgkmcnt(0)
  v_lshlrev_b32 v226, 16, v106
  v_and_b32 v227, 0xffff0000, v106
  v_pk_add_f32 v[56:57], v[224:225], v[226:227]
  v_pk_add_f32 v[72:73], v[224:225], v[226:227] neg_lo:[0,1] neg_hi:[0,1]
  v_lshlrev_b32 v228, 16, v105
  v_and_b32 v229, 0xffff0000, v105
  v_lshlrev_b32 v230, 16, v107
  v_and_b32 v231, 0xffff0000, v107
  v_pk_add_f32 v[58:59], v[228:229], v[230:231]
  v_pk_add_f32 v[74:75], v[228:229], v[230:231] neg_lo:[0,1] neg_hi:[0,1]
  s_cmp_eq_u32 s48, 7
  s_cbranch_scc1 L_sp_end
  s_cmp_lt_u32 s48, 4
  s_cbranch_scc0 L_sk45
  s_setprio 1
L_sk45:
  ds_read_b128 v[172:175], v208 offset:0
  ds_read_b128 v[176:179], v208 offset:8192
  ds_read_b128 v[180:183], v208 offset:16384
  ds_read_b128 v[184:187], v208 offset:1024
  ds_read_b128 v[188:191], v208 offset:9216
  ds_read_b128 v[192:195], v208 offset:17408
  s_mov_b32 s62, 0
L_poll46:
  s_mov_b32 s13, 0
  s_atomic_add s13, s[22:23], s65 glc
  s_add_u32 s62, s62, 1
  s_waitcnt lgkmcnt(0)
  s_cmp_gt_u32 s62, 0x8000
  s_cbranch_scc1 L_pend47
  s_cmp_lt_u32 s13, 16
  s_cbranch_scc1 L_poll46
L_pend47:
  s_add_u32 m0, s60, 0
  s_add_u32 s56, s69, 0
  buffer_load_dwordx4 v212, s[32:35], s56 offen offset:0 sc1 lds
  buffer_load_dwordx4 v212, s[32:35], s56 offen offset:1024 sc1 lds
  buffer_load_dwordx4 v212, s[32:35], s56 offen offset:2048 sc1 lds
  buffer_load_dwordx4 v212, s[32:35], s56 offen offset:3072 sc1 lds
  s_add_u32 m0, s60, 4096
  s_add_u32 s56, s69, 4096
  buffer_load_dwordx4 v212, s[32:35], s56 offen offset:0 sc1 lds
  buffer_load_dwordx4 v212, s[32:35], s56 offen offset:1024 sc1 lds
  buffer_load_dwordx4 v212, s[32:35], s56 offen offset:2048 sc1 lds
  buffer_load_dwordx4 v212, s[32:35], s56 offen offset:3072 sc1 lds
  s_waitcnt vmcnt(6)
  ds_read_b64_tr_b16 v[76:77], v210 offset:0
  ds_read_b64_tr_b16 v[78:79], v210 offset:1024
  ds_read_b64_tr_b16 v[92:93], v211 offset:0
  ds_read_b64_tr_b16 v[94:95], v211 offset:1024
  s_waitcnt vmcnt(4)
  ds_read_b64_tr_b16 v[80:81], v210 offset:2048
  ds_read_b64_tr_b16 v[82:83], v210 offset:3072
  ds_read_b64_tr_b16 v[96:97], v211 offset:2048
  ds_read_b64_tr_b16 v[98:99], v211 offset:3072
  s_waitcnt lgkmcnt(6)
  v_mfma_f32_32x32x16_bf16 v[108:123], v[172:175], v[76:79], 0
  s_waitcnt vmcnt(2)
  ds_read_b64_tr_b16 v[84:85], v210 offset:4096
  ds_read_b64_tr_b16 v[86:87], v210 offset:5120
  ds_read_b64_tr_b16 v[100:101], v211 offset:4096
  ds_read_b64_tr_b16 v[102:103], v211 offset:5120
  s_waitcnt lgkmcnt(8)
  v_mfma_f32_32x32x16_bf16 v[124:139], v[172:175], v[92:95], 0
  ds_read_b128 v[196:199], v208 offset:2048
  ds_read_b128 v[200:203], v208 offset:10240
  ds_read_b128 v[204:207], v208 offset:18432
  v_mfma_f32_32x32x16_bf16 v[108:123], v[176:179], v[92:95], v[108:123]
  v_mfma_f32_32x32x16_bf16 v[124:139], v[180:183], v[76:79], v[124:139]
  s_waitcnt lgkmcnt(9)
  v_mfma_f32_32x32x16_bf16 v[108:123], v[184:187], v[80:83], v[108:123]
  s_waitcnt vmcnt(0)
  ds_read_b64_tr_b16 v[88:89], v210 offset:6144
  ds_read_b64_tr_b16 v[90:91], v210 offset:7168
  ds_read_b64_tr_b16 v[104:105], v211 offset:6144
  ds_read_b64_tr_b16 v[106:107], v211 offset:7168
  s_waitcnt lgkmcnt(11)
  v_mfma_f32_32x32x16_bf16 v[124:139], v[184:187], v[96:99], v[124:139]
  ds_read_b128 v[172:175], v208 offset:3072
  ds_read_b128 v[176:179], v208 offset:11264
  ds_read_b128 v[180:183], v208 offset:19456
  v_mfma_f32_32x32x16_bf16 v[108:123], v[188:191], v[96:99], v[108:123]
  v_mfma_f32_32x32x16_bf16 v[124:139], v[192:195], v[80:83], v[124:139]
  s_waitcnt lgkmcnt(9)
  v_mfma_f32_32x32x16_bf16 v[140:155], v[196:199], v[84:87], 0
  v_mfma_f32_32x32x16_bf16 v[156:171], v[196:199], v[100:103], 0
  ds_read_b128 v[184:187], v208 offset:4096
  ds_read_b128 v[188:191], v208 offset:12288
  ds_read_b128 v[192:195], v208 offset:20480
  s_waitcnt lgkmcnt(11)
  v_mfma_f32_32x32x16_bf16 v[140:155], v[200:203], v[100:103], v[140:155]
  s_waitcnt lgkmcnt(10)
  v_mfma_f32_32x32x16_bf16 v[156:171], v[204:207], v[84:87], v[156:171]
  s_waitcnt lgkmcnt(5)
  v_mfma_f32_32x32x16_bf16 v[140:155], v[172:175], v[88:91], v[140:155]
  v_mfma_f32_32x32x16_bf16 v[156:171], v[172:175], v[104:107], v[156:171]
  ds_read_b128 v[196:199], v208 offset:5120
  ds_read_b128 v[200:203], v208 offset:13312
  ds_read_b128 v[204:207], v208 offset:21504
  s_waitcnt lgkmcnt(7)
  v_mfma_f32_32x32x16_bf16 v[140:155], v[176:179], v[104:107], v[140:155]
  s_waitcnt lgkmcnt(6)
  v_mfma_f32_32x32x16_bf16 v[156:171], v[180:183], v[88:91], v[156:171]
  v_pk_mul_f32 v[224:225], v[108:109], v[12:13]
  v_pk_mul_f32 v[226:227], v[108:109], v[44:45]
  v_pk_mul_f32 v[228:229], v[108:109], v[28:29]
  v_pk_mul_f32 v[230:231], v[108:109], v[60:61]
  v_pk_fma_f32 v[224:225], v[124:125], v[44:45], v[224:225] neg_lo:[1,0,0] neg_hi:[1,0,0]
  v_pk_fma_f32 v[226:227], v[124:125], v[12:13], v[226:227]
  v_pk_fma_f32 v[228:229], v[124:125], v[60:61], v[228:229] neg_lo:[1,0,0] neg_hi:[1,0,0]
  v_pk_fma_f32 v[230:231], v[124:125], v[28:29], v[230:231]
  s_nop 1
  v_pk_fma_f32 v[224:225], v[140:141], v[28:29], v[224:225]
  v_pk_fma_f32 v[226:227], v[140:141], v[60:61], v[226:227]
  v_pk_fma_f32 v[228:229], v[140:141], v[12:13], v[228:229]
  v_pk_fma_f32 v[230:231], v[140:141], v[44:45], v[230:231]
  v_pk_fma_f32 v[224:225], v[156:157], v[60:61], v[224:225] neg_lo:[1,0,0] neg_hi:[1,0,0]
  v_pk_fma_f32 v[226:227], v[156:157], v[28:29], v[226:227]
  v_pk_fma_f32 v[228:229], v[156:157], v[44:45], v[228:229] neg_lo:[1,0,0] neg_hi:[1,0,0]
  v_pk_fma_f32 v[230:231], v[156:157], v[12:13], v[230:231]
  v_cvt_pk_bf16_f32 v76, v224, v225
  v_cvt_pk_bf16_f32 v84, v226, v227
  v_cvt_pk_bf16_f32 v92, v228, v229
  v_cvt_pk_bf16_f32 v100, v230, v231
  v_pk_mul_f32 v[232:233], v[110:111], v[14:15]
  v_pk_mul_f32 v[234:235], v[110:111], v[46:47]
  v_pk_mul_f32 v[236:237], v[110:111], v[30:31]
  v_pk_mul_f32 v[238:239], v[110:111], v[62:63]
  v_pk_fma_f32 v[232:233], v[126:127], v[46:47], v[232:233] neg_lo:[1,0,0] neg_hi:[1,0,0]
  v_pk_fma_f32 v[234:235], v[126:127], v[14:15], v[234:235]
  v_pk_fma_f32 v[236:237], v[126:127], v[62:63], v[236:237] neg_lo:[1,0,0] neg_hi:[1,0,0]
  v_pk_fma_f32 v[238:239], v[126:127], v[30:31], v[238:239]
  v_pk_fma_f32 v[232:233], v[142:143], v[30:31], v[232:233]
  v_pk_fma_f32 v[234:235], v[142:143], v[62:63], v[234:235]
  v_pk_fma_f32 v[236:237], v[142:143], v[14:15], v[236:237]
  v_pk_fma_f32 v[238:239], v[142:143], v[46:47], v[238:239]
  v_pk_fma_f32 v[232:233], v[158:159], v[62:63], v[232:233] neg_lo:[1,0,0] neg_hi:[1,0,0]
  v_pk_fma_f32 v[234:235], v[158:159], v[30:31], v[234:235]
  v_pk_fma_f32 v[236:237], v[158:159], v[46:47], v[236:237] neg_lo:[1,0,0] neg_hi:[1,0,0]
  v_pk_fma_f32 v[238:239], v[158:159], v[14:15], v[238:239]
  v_cvt_pk_bf16_f32 v77, v232, v233
  v_cvt_pk_bf16_f32 v85, v234, v235
  v_cvt_pk_bf16_f32 v93, v236, v237
  v_cvt_pk_bf16_f32 v101, v238, v239
  v_pk_mul_f32 v[224:225], v[112:113], v[16:17]
  v_pk_mul_f32 v[226:227], v[112:113], v[48:49]
  v_pk_mul_f32 v[228:229], v[112:113], v[32:33]
  v_pk_mul_f32 v[230:231], v[112:113], v[64:65]
  v_pk_fma_f32 v[224:225], v[128:129], v[48:49], v[224:225] neg_lo:[1,0,0] neg_hi:[1,0,0]
  v_pk_fma_f32 v[226:227], v[128:129], v[16:17], v[226:227]
  v_pk_fma_f32 v[228:229], v[128:129], v[64:65], v[228:229] neg_lo:[1,0,0] neg_hi:[1,0,0]
  v_pk_fma_f32 v[230:231], v[128:129], v[32:33], v[230:231]
  v_pk_fma_f32 v[224:225], v[144:145], v[32:33], v[224:225]
  v_pk_fma_f32 v[226:227], v[144:145], v[64:65], v[226:227]
  v_pk_fma_f32 v[228:229], v[144:145], v[16:17], v[228:229]
  v_pk_fma_f32 v[230:231], v[144:145], v[48:49], v[230:231]
  v_pk_fma_f32 v[224:225], v[160:161], v[64:65], v[224:225] neg_lo:[1,0,0] neg_hi:[1,0,0]
  v_pk_fma_f32 v[226:227], v[160:161], v[32:33], v[226:227]
  v_pk_fma_f32 v[228:229], v[160:161], v[48:49], v[228:229] neg_lo:[1,0,0] neg_hi:[1,0,0]
  v_pk_fma_f32 v[230:231], v[160:161], v[16:17], v[230:231]
  v_cvt_pk_bf16_f32 v78, v224, v225
  v_cvt_pk_bf16_f32 v86, v226, v227
  v_cvt_pk_bf16_f32 v94, v228, v229
  v_cvt_pk_bf16_f32 v102, v230, v231
  v_pk_mul_f32 v[232:233], v[114:115], v[18:19]
  v_pk_mul_f32 v[234:235], v[114:115], v[50:51]
  v_pk_mul_f32 v[236:237], v[114:115], v[34:35]
  v_pk_mul_f32 v[238:239], v[114:115], v[66:67]
  v_pk_fma_f32 v[232:233], v[130:131], v[50:51], v[232:233] neg_lo:[1,0,0] neg_hi:[1,0,0]
  v_pk_fma_f32 v[234:235], v[130:131], v[18:19], v[234:235]
  v_pk_fma_f32 v[236:237], v[130:131], v[66:67], v[236:237] neg_lo:[1,0,0] neg_hi:[1,0,0]
  v_pk_fma_f32 v[238:239], v[130:131], v[34:35], v[238:239]
  v_pk_fma_f32 v[232:233], v[146:147], v[34:35], v[232:233]
  v_pk_fma_f32 v[234:235], v[146:147], v[66:67], v[234:235]
  v_pk_fma_f32 v[236:237], v[146:147], v[18:19], v[236:237]
  v_pk_fma_f32 v[238:239], v[146:147], v[50:51], v[238:239]
  v_pk_fma_f32 v[232:233], v[162:163], v[66:67], v[232:233] neg_lo:[1,0,0] neg_hi:[1,0,0]
  v_pk_fma_f32 v[234:235], v[162:163], v[34:35], v[234:235]
  v_pk_fma_f32 v[236:237], v[162:163], v[50:51], v[236:237] neg_lo:[1,0,0] neg_hi:[1,0,0]
  v_pk_fma_f32 v[238:239], v[162:163], v[18:19], v[238:239]
  v_cvt_pk_bf16_f32 v79, v232, v233
  v_cvt_pk_bf16_f32 v87, v234, v235
  v_cvt_pk_bf16_f32 v95, v236, v237
  v_cvt_pk_bf16_f32 v103, v238, v239
  v_pk_mul_f32 v[224:225], v[116:117], v[20:21]
  v_pk_mul_f32 v[226:227], v[116:117], v[52:53]
  v_pk_mul_f32 v[228:229], v[116:117], v[36:37]
  v_pk_mul_f32 v[230:231], v[116:117], v[68:69]
  v_pk_fma_f32 v[224:225], v[132:133], v[52:53], v[224:225] neg_lo:[1,0,0] neg_hi:[1,0,0]
  v_pk_fma_f32 v[226:227], v[132:133], v[20:21], v[226:227]
  v_pk_fma_f32 v[228:229], v[132:133], v[68:69], v[228:229] neg_lo:[1,0,0] neg_hi:[1,0,0]
  v_pk_fma_f32 v[230:231], v[132:133], v[36:37], v[230:231]
  v_pk_fma_f32 v[224:225], v[148:149], v[36:37], v[224:225]
  v_pk_fma_f32 v[226:227], v[148:149], v[68:69], v[226:227]
  v_pk_fma_f32 v[228:229], v[148:149], v[20:21], v[228:229]
  v_pk_fma_f32 v[230:231], v[148:149], v[52:53], v[230:231]
  v_pk_fma_f32 v[224:225], v[164:165], v[68:69], v[224:225] neg_lo:[1,0,0] neg_hi:[1,0,0]
  v_pk_fma_f32 v[226:227], v[164:165], v[36:37], v[226:227]
  v_pk_fma_f32 v[228:229], v[164:165], v[52:53], v[228:229] neg_lo:[1,0,0] neg_hi:[1,0,0]
  v_pk_fma_f32 v[230:231], v[164:165], v[20:21], v[230:231]
  v_cvt_pk_bf16_f32 v80, v224, v225
  v_cvt_pk_bf16_f32 v88, v226, v227
  v_cvt_pk_bf16_f32 v96, v228, v229
  v_cvt_pk_bf16_f32 v104, v230, v231
  v_pk_mul_f32 v[232:233], v[118:119], v[22:23]
  v_pk_mul_f32 v[234:235], v[118:119], v[54:55]
  v_pk_mul_f32 v[236:237], v[118:119], v[38:39]
  v_pk_mul_f32 v[238:239], v[118:119], v[70:71]
  v_pk_fma_f32 v[232:233], v[134:135], v[54:55], v[232:233] neg_lo:[1,0,0] neg_hi:[1,0,0]
  v_pk_fma_f32 v[234:235], v[134:135], v[22:23], v[234:235]
  v_pk_fma_f32 v[236:237], v[134:135], v[70:71], v[236:237] neg_lo:[1,0,0] neg_hi:[1,0,0]
  v_pk_fma_f32 v[238:239], v[134:135], v[38:39], v[238:239]
  v_pk_fma_f32 v[232:233], v[150:151], v[38:39], v[232:233]
  v_pk_fma_f32 v[234:235], v[150:151], v[70:71], v[234:235]
  v_pk_fma_f32 v[236:237], v[150:151], v[22:23], v[236:237]
  v_pk_fma_f32 v[238:239], v[150:151], v[54:55], v[238:239]
  v_pk_fma_f32 v[232:233], v[166:167], v[70:71], v[232:233] neg_lo:[1,0,0] neg_hi:[1,0,0]
  v_pk_fma_f32 v[234:235], v[166:167], v[38:39], v[234:235]
  v_pk_fma_f32 v[236:237], v[166:167], v[54:55], v[236:237] neg_lo:[1,0,0] neg_hi:[1,0,0]
  v_pk_fma_f32 v[238:239], v[166:167], v[22:23], v[238:239]
  v_cvt_pk_bf16_f32 v81, v232, v233
  v_cvt_pk_bf16_f32 v89, v234, v235
  v_cvt_pk_bf16_f32 v97, v236, v237
  v_cvt_pk_bf16_f32 v105, v238, v239
  v_pk_mul_f32 v[224:225], v[120:121], v[24:25]
  v_pk_mul_f32 v[226:227], v[120:121], v[56:57]
  v_pk_mul_f32 v[228:229], v[120:121], v[40:41]
  v_pk_mul_f32 v[230:231], v[120:121], v[72:73]
  v_pk_fma_f32 v[224:225], v[136:137], v[56:57], v[224:225] neg_lo:[1,0,0] neg_hi:[1,0,0]
  v_pk_fma_f32 v[226:227], v[136:137], v[24:25], v[226:227]
  v_pk_fma_f32 v[228:229], v[136:137], v[72:73], v[228:229] neg_lo:[1,0,0] neg_hi:[1,0,0]
  v_pk_fma_f32 v[230:231], v[136:137], v[40:41], v[230:231]
  v_pk_fma_f32 v[224:225], v[152:153], v[40:41], v[224:225]
  v_pk_fma_f32 v[226:227], v[152:153], v[72:73], v[226:227]
  v_pk_fma_f32 v[228:229], v[152:153], v[24:25], v[228:229]
  v_pk_fma_f32 v[230:231], v[152:153], v[56:57], v[230:231]
  v_pk_fma_f32 v[224:225], v[168:169], v[72:73], v[224:225] neg_lo:[1,0,0] neg_hi:[1,0,0]
  v_pk_fma_f32 v[226:227], v[168:169], v[40:41], v[226:227]
  v_pk_fma_f32 v[228:229], v[168:169], v[56:57], v[228:229] neg_lo:[1,0,0] neg_hi:[1,0,0]
  v_pk_fma_f32 v[230:231], v[168:169], v[24:25], v[230:231]
  v_cvt_pk_bf16_f32 v82, v224, v225
  v_cvt_pk_bf16_f32 v90, v226, v227
  v_cvt_pk_bf16_f32 v98, v228, v229
  v_cvt_pk_bf16_f32 v106, v230, v231
  v_pk_mul_f32 v[232:233], v[122:123], v[26:27]
  v_pk_mul_f32 v[234:235], v[122:123], v[58:59]
  v_pk_mul_f32 v[236:237], v[122:123], v[42:43]
  v_pk_mul_f32 v[238:239], v[122:123], v[74:75]
  v_pk_fma_f32 v[232:233], v[138:139], v[58:59], v[232:233] neg_lo:[1,0,0] neg_hi:[1,0,0]
  v_pk_fma_f32 v[234:235], v[138:139], v[26:27], v[234:235]
  v_pk_fma_f32 v[236:237], v[138:139], v[74:75], v[236:237] neg_lo:[1,0,0] neg_hi:[1,0,0]
  v_pk_fma_f32 v[238:239], v[138:139], v[42:43], v[238:239]
  v_pk_fma_f32 v[232:233], v[154:155], v[42:43], v[232:233]
  v_pk_fma_f32 v[234:235], v[154:155], v[74:75], v[234:235]
  v_pk_fma_f32 v[236:237], v[154:155], v[26:27], v[236:237]
  v_pk_fma_f32 v[238:239], v[154:155], v[58:59], v[238:239]
  v_pk_fma_f32 v[232:233], v[170:171], v[74:75], v[232:233] neg_lo:[1,0,0] neg_hi:[1,0,0]
  v_pk_fma_f32 v[234:235], v[170:171], v[42:43], v[234:235]
  v_pk_fma_f32 v[236:237], v[170:171], v[58:59], v[236:237] neg_lo:[1,0,0] neg_hi:[1,0,0]
  v_pk_fma_f32 v[238:239], v[170:171], v[26:27], v[238:239]
  v_cvt_pk_bf16_f32 v83, v232, v233
  v_cvt_pk_bf16_f32 v91, v234, v235
  v_cvt_pk_bf16_f32 v99, v236, v237
  v_cvt_pk_bf16_f32 v107, v238, v239
  ds_read_b128 v[172:175], v208 offset:6144
  ds_read_b128 v[176:179], v208 offset:14336
  ds_read_b128 v[180:183], v208 offset:22528
  ds_read_b128 v[12:15], v208 offset:7168
  ds_read_b128 v[16:19], v208 offset:15360
  ds_read_b128 v[20:23], v208 offset:23552
  s_waitcnt lgkmcnt(11)
  v_mfma_f32_32x32x16_bf16 v[108:123], v[76:79], v[184:187], 0
  v_mfma_f32_32x32x16_bf16 v[140:155], v[84:87], v[184:187], 0
  s_waitcnt lgkmcnt(9)
  v_mfma_f32_32x32x16_bf16 v[108:123], v[84:87], v[192:195], v[108:123]
  v_mfma_f32_32x32x16_bf16 v[140:155], v[76:79], v[188:191], v[140:155]
  s_waitcnt lgkmcnt(8)
  v_mfma_f32_32x32x16_bf16 v[108:123], v[80:83], v[196:199], v[108:123]
  v_mfma_f32_32x32x16_bf16 v[140:155], v[88:91], v[196:199], v[140:155]
  s_waitcnt lgkmcnt(6)
  v_mfma_f32_32x32x16_bf16 v[108:123], v[88:91], v[204:207], v[108:123]
  v_mfma_f32_32x32x16_bf16 v[140:155], v[80:83], v[200:203], v[140:155]
  s_waitcnt lgkmcnt(5)
  v_mfma_f32_32x32x16_bf16 v[124:139], v[92:95], v[172:175], 0
  v_mfma_f32_32x32x16_bf16 v[156:171], v[100:103], v[172:175], 0
  s_waitcnt lgkmcnt(3)
  v_mfma_f32_32x32x16_bf16 v[124:139], v[100:103], v[180:183], v[124:139]
  v_mfma_f32_32x32x16_bf16 v[156:171], v[92:95], v[176:179], v[156:171]
  s_waitcnt lgkmcnt(2)
  v_mfma_f32_32x32x16_bf16 v[124:139], v[96:99], v[12:15], v[124:139]
  v_mfma_f32_32x32x16_bf16 v[156:171], v[104:107], v[12:15], v[156:171]
  s_waitcnt lgkmcnt(0)
  v_mfma_f32_32x32x16_bf16 v[124:139], v[104:107], v[20:23], v[124:139]
  v_mfma_f32_32x32x16_bf16 v[156:171], v[96:99], v[16:19], v[156:171]
  s_nop 11
  s_cmp_eq_u32 s50, 0
  s_cbranch_scc1 L_k48
  v_pk_add_f32 v[24:25], v[140:141], v[148:149] neg_lo:[0,1] neg_hi:[0,1]
  v_pk_add_f32 v[140:141], v[140:141], v[148:149]
  v_pk_add_f32 v[148:149], v[116:117], v[108:109] neg_lo:[0,1] neg_hi:[0,1]
  v_pk_add_f32 v[108:109], v[108:109], v[116:117]
  v_pk_add_f32 v[26:27], v[142:143], v[150:151] neg_lo:[0,1] neg_hi:[0,1]
  v_pk_add_f32 v[142:143], v[142:143], v[150:151]
  v_pk_add_f32 v[150:151], v[118:119], v[110:111] neg_lo:[0,1] neg_hi:[0,1]
  v_pk_add_f32 v[110:111], v[110:111], v[118:119]
  v_pk_add_f32 v[28:29], v[144:145], v[152:153] neg_lo:[0,1] neg_hi:[0,1]
  v_pk_add_f32 v[144:145], v[144:145], v[152:153]
  v_pk_add_f32 v[152:153], v[120:121], v[112:113] neg_lo:[0,1] neg_hi:[0,1]
  v_pk_add_f32 v[112:113], v[112:113], v[120:121]
  v_pk_add_f32 v[30:31], v[146:147], v[154:155] neg_lo:[0,1] neg_hi:[0,1]
  v_pk_add_f32 v[146:147], v[146:147], v[154:155]
  v_pk_add_f32 v[154:155], v[122:123], v[114:115] neg_lo:[0,1] neg_hi:[0,1]
  v_pk_add_f32 v[114:115], v[114:115], v[122:123]
  v_pk_add_f32 v[32:33], v[156:157], v[164:165] neg_lo:[0,1] neg_hi:[0,1]
  v_pk_add_f32 v[156:157], v[156:157], v[164:165]
  v_pk_add_f32 v[164:165], v[132:133], v[124:125] neg_lo:[0,1] neg_hi:[0,1]
  v_pk_add_f32 v[124:125], v[124:125], v[132:133]
  v_pk_add_f32 v[34:35], v[158:159], v[166:167] neg_lo:[0,1] neg_hi:[0,1]
  v_pk_add_f32 v[158:159], v[158:159], v[166:167]
  v_pk_add_f32 v[166:167], v[134:135], v[126:127] neg_lo:[0,1] neg_hi:[0,1]
  v_pk_add_f32 v[126:127], v[126:127], v[134:135]
  v_pk_add_f32 v[36:37], v[160:161], v[168:169] neg_lo:[0,1] neg_hi:[0,1]
  v_pk_add_f32 v[160:161], v[160:161], v[168:169]
  v_pk_add_f32 v[168:169], v[136:137], v[128:129] neg_lo:[0,1] neg_hi:[0,1]
  v_pk_add_f32 v[128:129], v[128:129], v[136:137]
  v_pk_add_f32 v[38:39], v[162:163], v[170:171] neg_lo:[0,1] neg_hi:[0,1]
  v_pk_add_f32 v[162:163], v[162:163], v[170:171]
  v_pk_add_f32 v[170:171], v[138:139], v[130:131] neg_lo:[0,1] neg_hi:[0,1]
  v_pk_add_f32 v[130:131], v[130:131], v[138:139]
L_k49:
  s_cmp_eq_u32 s52, 13
  s_cbranch_scc0 L_k50
  s_mov_b32 exec_lo, 0
  v_mul_f32 v224, 0.5, v112
  v_fma_f32 v144, v143, 0.5, -v224
  v_fma_f32 v143, v143, 0.5, v224
  v_fma_f32 v112, v111, 0.5, -v224
  v_fma_f32 v111, v111, 0.5, v224
  v_mul_f32 v224, 0.5, v28
  v_fma_f32 v152, v151, 0.5, -v224
  v_fma_f32 v151, v151, 0.5, v224
  v_fma_f32 v28, v27, 0.5, -v224
  v_fma_f32 v27, v27, 0.5, v224
  v_mul_f32 v224, 0.5, v128
  v_fma_f32 v160, v159, 0.5, -v224
  v_fma_f32 v159, v159, 0.5, v224
  v_fma_f32 v128, v127, 0.5, -v224
  v_fma_f32 v127, v127, 0.5, v224
  v_mul_f32 v224, 0.5, v36
  v_fma_f32 v168, v167, 0.5, -v224
  v_fma_f32 v167, v167, 0.5, v224
  v_fma_f32 v36, v35, 0.5, -v224
  v_fma_f32 v35, v35, 0.5, v224
  s_mov_b64 exec, -1
L_k50:
  v_add_f32 v224, v108, v115
  v_add_f32 v225, v109, v114
  v_add_f32 v226, v110, v113
  v_add_f32 v227, v111, v112
  v_sub_f32 v228, v140, v147
  v_sub_f32 v229, v141, v146
  v_sub_f32 v230, v142, v145
  v_sub_f32 v231, v143, v144
  v_cvt_pk_bf16_f32 v76, v224, v225
  v_cvt_pk_bf16_f32 v77, v226, v227
  v_cvt_pk_bf16_f32 v78, v228, v229
  v_cvt_pk_bf16_f32 v79, v230, v231
  ds_write_b128 v216, v[76:79] offset:0
  v_add_f32 v232, v24, v31
  v_add_f32 v233, v25, v30
  v_add_f32 v234, v26, v29
  v_add_f32 v235, v27, v28
  v_sub_f32 v236, v148, v155
  v_sub_f32 v237, v149, v154
  v_sub_f32 v238, v150, v153
  v_sub_f32 v239, v151, v152
  v_cvt_pk_bf16_f32 v80, v232, v233
  v_cvt_pk_bf16_f32 v81, v234, v235
  v_cvt_pk_bf16_f32 v82, v236, v237
  v_cvt_pk_bf16_f32 v83, v238, v239
  ds_write_b128 v217, v[80:83] offset:0
  v_add_f32 v224, v124, v131
  v_add_f32 v225, v125, v130
  v_add_f32 v226, v126, v129
  v_add_f32 v227, v127, v128
  v_sub_f32 v228, v156, v163
  v_sub_f32 v229, v157, v162
  v_sub_f32 v230, v158, v161
  v_sub_f32 v231, v159, v160
  v_cvt_pk_bf16_f32 v84, v224, v225
  v_cvt_pk_bf16_f32 v85, v226, v227
  v_cvt_pk_bf16_f32 v86, v228, v229
  v_cvt_pk_bf16_f32 v87, v230, v231
  ds_write_b128 v218, v[84:87] offset:0
  v_add_f32 v232, v32, v39
  v_add_f32 v233, v33, v38
  v_add_f32 v234, v34, v37
  v_add_f32 v235, v35, v36
  v_sub_f32 v236, v164, v171
  v_sub_f32 v237, v165, v170
  v_sub_f32 v238, v166, v169
  v_sub_f32 v239, v167, v168
  v_cvt_pk_bf16_f32 v88, v232, v233
  v_cvt_pk_bf16_f32 v89, v234, v235
  v_cvt_pk_bf16_f32 v90, v236, v237
  v_cvt_pk_bf16_f32 v91, v238, v239
  ds_write_b128 v219, v[88:91] offset:0
  ds_read_b128 v[44:47], v220 offset:0
  ds_read_b128 v[48:51], v220 offset:1024
  ds_read_b128 v[52:55], v220 offset:2048
  ds_read_b128 v[56:59], v220 offset:3072
  v_sub_f32 v224, v108, v115
  v_sub_f32 v225, v109, v114
  v_sub_f32 v226, v110, v113
  v_sub_f32 v227, v111, v112
  v_add_f32 v228, v140, v147
  v_add_f32 v229, v141, v146
  v_add_f32 v230, v142, v145
  v_add_f32 v231, v143, v144
  v_cvt_pk_bf16_f32 v92, v224, v225
  v_cvt_pk_bf16_f32 v93, v226, v227
  v_cvt_pk_bf16_f32 v94, v228, v229
  v_cvt_pk_bf16_f32 v95, v230, v231
  ds_write_b128 v216, v[92:95] offset:4096
  v_sub_f32 v232, v24, v31
  v_sub_f32 v233, v25, v30
  v_sub_f32 v234, v26, v29
  v_sub_f32 v235, v27, v28
  v_add_f32 v236, v148, v155
  v_add_f32 v237, v149, v154
  v_add_f32 v238, v150, v153
  v_add_f32 v239, v151, v152
  v_cvt_pk_bf16_f32 v96, v232, v233
  v_cvt_pk_bf16_f32 v97, v234, v235
  v_cvt_pk_bf16_f32 v98, v236, v237
  v_cvt_pk_bf16_f32 v99, v238, v239
  ds_write_b128 v217, v[96:99] offset:4096
  s_add_u32 s56, s64, 0
  s_waitcnt lgkmcnt(5)
  buffer_store_dwordx4 v[44:47], v213, s[32:35], s56 offen sc1
  v_sub_f32 v224, v124, v131
  v_sub_f32 v225, v125, v130
  v_sub_f32 v226, v126, v129
  v_sub_f32 v227, v127, v128
  v_add_f32 v228, v156, v163
  v_add_f32 v229, v157, v162
  v_add_f32 v230, v158, v161
  v_add_f32 v231, v159, v160
  v_cvt_pk_bf16_f32 v100, v224, v225
  v_cvt_pk_bf16_f32 v101, v226, v227
  v_cvt_pk_bf16_f32 v102, v228, v229
  v_cvt_pk_bf16_f32 v103, v230, v231
  ds_write_b128 v218, v[100:103] offset:4096
  s_add_u32 s56, s64, 458752
  s_waitcnt lgkmcnt(5)
  buffer_store_dwordx4 v[48:51], v213, s[32:35], s56 offen sc1
  v_sub_f32 v232, v32, v39
  v_sub_f32 v233, v33, v38
  v_sub_f32 v234, v34, v37
  v_sub_f32 v235, v35, v36
  v_add_f32 v236, v164, v171
  v_add_f32 v237, v165, v170
  v_add_f32 v238, v166, v169
  v_add_f32 v239, v167, v168
  v_cvt_pk_bf16_f32 v104, v232, v233
  v_cvt_pk_bf16_f32 v105, v234, v235
  v_cvt_pk_bf16_f32 v106, v236, v237
  v_cvt_pk_bf16_f32 v107, v238, v239
  ds_write_b128 v219, v[104:107] offset:4096
  s_add_u32 s56, s64, 917504
  s_waitcnt lgkmcnt(5)
  buffer_store_dwordx4 v[52:55], v213, s[32:35], s56 offen sc1
  ds_read_b128 v[60:63], v220 offset:4096
  ds_read_b128 v[64:67], v220 offset:5120
  ds_read_b128 v[68:71], v220 offset:6144
  ds_read_b128 v[72:75], v220 offset:7168
  s_add_u32 s56, s64, 1376256
  s_waitcnt lgkmcnt(8)
  buffer_store_dwordx4 v[56:59], v213, s[32:35], s56 offen sc1
  s_add_u32 s56, s64, 28672
  s_waitcnt lgkmcnt(3)
  buffer_store_dwordx4 v[60:63], v213, s[32:35], s56 offen sc1
  s_add_u32 s56, s64, 487424
  s_waitcnt lgkmcnt(2)
  buffer_store_dwordx4 v[64:67], v213, s[32:35], s56 offen sc1
  s_add_u32 s56, s64, 946176
  s_waitcnt lgkmcnt(1)
  buffer_store_dwordx4 v[68:71], v213, s[32:35], s56 offen sc1
  s_add_u32 s56, s64, 1404928
  s_waitcnt lgkmcnt(0)
  buffer_store_dwordx4 v[72:75], v213, s[32:35], s56 offen sc1
  s_waitcnt vmcnt(0)
  s_cmp_lt_u32 s48, 4
  s_cbranch_scc0 L_sk51
  s_setprio 0
  v_mov_b32 v8, 139208
  v_mov_b32 v7, 1
  s_mov_b64 exec, 1
  ds_add_u32 v8, v7
  s_mov_b64 exec, -1
  v_mov_b32 v8, 139208
  s_mov_b32 s62, 0
L_lw52:
  ds_read_b32 v7, v8
  s_add_u32 s62, s62, 1
  s_cmp_gt_u32 s62, 0x40000
  s_cbranch_scc1 L_lwe53
  s_waitcnt lgkmcnt(0)
  v_cmp_gt_u32 vcc, 4, v7
  s_cbranch_vccnz L_lw52
L_lwe53:
  s_waitcnt lgkmcnt(0)
  v_mov_b32 v3, 1
  s_mov_b32 exec_hi, 0xffffff
  buffer_atomic_add v3, v209, s[32:35], 0 offen sc1
  s_mov_b64 exec, -1
  v_add_u32 v209, 4, v209
L_sk51:
  s_barrier
  s_cmp_lt_u32 s48, 4
  s_cbranch_scc0 L_sp_end
  v_mov_b32 v3, 1
  s_mov_b32 exec_hi, 0xffffff
  buffer_atomic_add v3, v209, s[32:35], 0 offen sc1
  s_mov_b64 exec, -1
L_sp_end:
  s_endpgm
L_k48:
  v_pk_mul_f32 v[24:25], v[116:117], v[240:241]
  v_pk_fma_f32 v[24:25], v[148:149], v[242:243], v[24:25] neg_lo:[1,0,0] neg_hi:[1,0,0]
  v_pk_mul_f32 v[148:149], v[148:149], v[240:241]
  v_pk_fma_f32 v[148:149], v[116:117], v[242:243], v[148:149]
  v_pk_mul_f32 v[26:27], v[118:119], v[240:241]
  v_pk_fma_f32 v[26:27], v[150:151], v[242:243], v[26:27] neg_lo:[1,0,0] neg_hi:[1,0,0]
  v_pk_mul_f32 v[150:151], v[150:151], v[240:241]
  v_pk_fma_f32 v[150:151], v[118:119], v[242:243], v[150:151]
  v_pk_mul_f32 v[28:29], v[120:121], v[240:241]
  v_pk_fma_f32 v[28:29], v[152:153], v[242:243], v[28:29] neg_lo:[1,0,0] neg_hi:[1,0,0]
  v_pk_mul_f32 v[152:153], v[152:153], v[240:241]
  v_pk_fma_f32 v[152:153], v[120:121], v[242:243], v[152:153]
  v_pk_mul_f32 v[30:31], v[122:123], v[240:241]
  v_pk_fma_f32 v[30:31], v[154:155], v[242:243], v[30:31] neg_lo:[1,0,0] neg_hi:[1,0,0]
  v_pk_mul_f32 v[154:155], v[154:155], v[240:241]
  v_pk_fma_f32 v[154:155], v[122:123], v[242:243], v[154:155]
  v_pk_mul_f32 v[32:33], v[132:133], v[244:245]
  v_pk_fma_f32 v[32:33], v[164:165], v[246:247], v[32:33] neg_lo:[1,0,0] neg_hi:[1,0,0]
  v_pk_mul_f32 v[164:165], v[164:165], v[244:245]
  v_pk_fma_f32 v[164:165], v[132:133], v[246:247], v[164:165]
  v_pk_mul_f32 v[34:35], v[134:135], v[244:245]
  v_pk_fma_f32 v[34:35], v[166:167], v[246:247], v[34:35] neg_lo:[1,0,0] neg_hi:[1,0,0]
  v_pk_mul_f32 v[166:167], v[166:167], v[244:245]
  v_pk_fma_f32 v[166:167], v[134:135], v[246:247], v[166:167]
  v_pk_mul_f32 v[36:37], v[136:137], v[244:245]
  v_pk_fma_f32 v[36:37], v[168:169], v[246:247], v[36:37] neg_lo:[1,0,0] neg_hi:[1,0,0]
  v_pk_mul_f32 v[168:169], v[168:169], v[244:245]
  v_pk_fma_f32 v[168:169], v[136:137], v[246:247], v[168:169]
  v_pk_mul_f32 v[38:39], v[138:139], v[244:245]
  v_pk_fma_f32 v[38:39], v[170:171], v[246:247], v[38:39] neg_lo:[1,0,0] neg_hi:[1,0,0]
  v_pk_mul_f32 v[170:171], v[170:171], v[244:245]
  v_pk_fma_f32 v[170:171], v[138:139], v[246:247], v[170:171]
  s_branch L_k49
L_exit:
  s_endpgm
L_code_end:
.section .rodata,"a"
.p2align 6
.amdhsa_kernel recurrent_scan__spectral_gfnet__glu_gated_glu__prompt_kernel
  .amdhsa_next_free_vgpr 256
  .amdhsa_next_free_sgpr 102
  .amdhsa_accum_offset 256
  .amdhsa_group_segment_fixed_size 0
  .amdhsa_kernarg_size 80
  .amdhsa_user_sgpr_count 2
  .amdhsa_user_sgpr_kernarg_segment_ptr 1
  .amdhsa_system_sgpr_workgroup_id_x 1
.end_amdhsa_kernel
```
